```python
import torch

def _softmax(x, axis=-1):
    return torch.softmax(x, dim=axis)
def _gelu(x):
    return torch.nn.functional.gelu(x, approximate="tanh")
def _silu(x):
    return torch.nn.functional.silu(x)
def _sigmoid(x):
    return torch.sigmoid(x)
def _layernorm(x, axis=-1, eps=1e-5):
    m = x.mean(dim=axis, keepdim=True)
    v = x.var(dim=axis, keepdim=True, unbiased=False)
    return (x - m) / torch.sqrt(v + eps)
def _scatter_add(tgt, idx, src, axis=0):
    return tgt.clone().index_add_(axis, idx, src)
def _segment_sum(src, seg, n):
    out = torch.zeros((n,) + src.shape[1:], dtype=src.dtype)
    return out.index_add_(0, seg, src)
def _pad(x, pw):
    flat = tuple(v for pair in reversed(pw) for v in pair)
    return torch.nn.functional.pad(x, flat)

kernel_name = 'concat_heads__softmax_full_mha__grouped_kv_mqa__prompt'

def setup_inputs():

    _w = (lambda a: (lambda t: t.to(torch.bfloat16) if t.is_floating_point() else t)(torch.as_tensor(a)))
    def _A_setup():
        B, S, D = 1, 2048, 640
        return {
            "x": _w((lambda *s: torch.randn(*s, dtype=torch.bfloat16) * 0.2)(B, S, D)),
            "wqkv": _w((lambda *s: torch.randn(*s, dtype=torch.bfloat16) * 0.2)(D, 3 * D)),
            "wo": _w((lambda *s: torch.randn(*s, dtype=torch.bfloat16) * 0.05)(D, D)),
        }
    _A_in = _A_setup()

    def _B_setup():
        B, S, D, H = 1, 2048, 640, 32
        Dh = D // H
        return {
            "x": _w((lambda *s: torch.randn(*s, dtype=torch.bfloat16) * 0.05)(B, S, D)),
            "wq": _w((lambda *s: torch.randn(*s, dtype=torch.bfloat16) * 0.8)(D, H * Dh)),
            "wk": _w((lambda *s: torch.randn(*s, dtype=torch.bfloat16) * 0.8)(D, Dh)),
            "wv": _w((lambda *s: torch.randn(*s, dtype=torch.bfloat16) * 0.1)(D, Dh)),
            "wo": _w((lambda *s: torch.randn(*s, dtype=torch.bfloat16) * 0.1)(H * Dh, D)),
        }
    _B_in = _B_setup()

    return {
        "A_x": _A_in["x"],
        "A_wqkv": _A_in["wqkv"],
        "A_wo": _A_in["wo"],
        "B_x": _B_in["x"],
        "B_wq": _B_in["wq"],
        "B_wk": _B_in["wk"],
        "B_wv": _B_in["wv"],
        "B_wo": _B_in["wo"],
    }

def reference(A_x, A_wqkv, A_wo, B_x, B_wq, B_wk, B_wv, B_wo):
    def _A_ref(x, wqkv, wo):
        B, S, D = x.shape
        H = 32; Dh = D // H
        qkv = (lambda x, *d: x.permute(*d))((x @ wqkv).reshape(B, S, 3, H, Dh), 2, 0, 3, 1, 4)
        q, k, v = qkv[0], qkv[1], qkv[2]
        scale = Dh ** -0.5
        scores = torch.einsum("bhqd,bhkd->bhqk", q, k) * scale
        p = _softmax(scores, axis=-1)
        o = torch.einsum("bhqk,bhkd->bhqd", p, v)
        return (lambda x, *d: x.permute(*d))(o, 0, 2, 1, 3).reshape(B, S, D) @ wo

    def _B_ref(x, wq, wk, wv, wo):
        B, S, D = x.shape
        H = 32
        Dh = D // H
        q = (lambda x, *d: x.permute(*d))((x @ wq).reshape(B, S, H, Dh), 0, 2, 1, 3)
        k = x @ wk
        v = x @ wv
        scores = torch.einsum("bhqd,bkd->bhqk", q, k) * (Dh ** -0.5)
        p = _softmax(scores, axis=-1)
        o = torch.einsum("bhqk,bkd->bhqd", p, v)
        return (lambda x, *d: x.permute(*d))(o, 0, 2, 1, 3).reshape(B, S, H * Dh) @ wo

    a = _A_ref(A_x, A_wqkv, A_wo)
    b = _B_ref(B_x, B_wq, B_wk, B_wv, B_wo)
    return torch.concatenate([a, b], axis=-1)
```

```asm
; @launch grid=(256,1,1) block=(576,1,1) lds=163840
.amdgcn_target "amdgcn-amd-amdhsa--gfx950"
.text
.globl concat_heads__softmax_full_mha__grouped_kv_mqa__prompt_kernel
.p2align 8
.type concat_heads__softmax_full_mha__grouped_kv_mqa__prompt_kernel,@function
concat_heads__softmax_full_mha__grouped_kv_mqa__prompt_kernel:
  s_cmp_ge_u32 s2, 256
  s_cbranch_scc1 KEND
  s_load_dwordx16 s[16:31], s[0:1], 0
  s_load_dwordx2 s[8:9], s[0:1], 80
  s_memrealtime s[6:7]
  v_and_b32 v1, 63, v0
  v_lshrrev_b32 v2, 6, v0
  s_and_b32 s50, s2, 7
  v_readfirstlane_b32 s3, v2
  s_lshr_b32 s51, s2, 3
  s_and_b32 s52, s51, 7
  s_lshr_b32 s53, s51, 3
  s_and_b32 s54, s50, 1
  s_lshr_b32 s55, s50, 1
  s_lshl_b32 s56, s54, 3
  s_add_u32 s56, s56, s52
  s_mov_b32 s10, 16777216
  s_mov_b32 s11, 0x00020000
  s_cmp_eq_u32 s55, 3
  s_cselect_b32 s57, 1, 0
  s_mov_b32 s58, 3840
  s_cselect_b32 s58, 1280, s58
  s_cselect_b32 s59, 0, s55
  s_mul_i32 s59, s59, 1280
  s_mul_i32 s60, s53, 320
  s_add_u32 s59, s59, s60
  s_cmp_ge_u32 s3, 4
  s_cbranch_scc1 P1_LOADER
  s_and_b32 s61, s3, 1
  s_lshr_b32 s62, s3, 1
  s_and_b32 s63, s53, s57
  v_and_b32 v2, 15, v1
  v_lshrrev_b32 v3, 4, v1
  s_cmp_eq_u32 s55, 2
  s_cselect_b64 s[64:65], -1, 0
  v_bfe_u32 v22, v2, 1, 3
  v_bfe_u32 v23, v2, 1, 1
  v_lshrrev_b32 v24, 2, v2
  v_lshl_or_b32 v23, v24, 1, v23
  v_cndmask_b32 v22, v22, v23, s[64:65]
  v_and_b32 v23, 3, v2
  v_lshl_add_u32 v23, v24, 3, v23
  v_cndmask_b32 v23, v2, v23, s[64:65]
  s_lshl_b32 s66, s61, 13
  s_lshl_b32 s67, s63, 12
  s_add_u32 s68, s66, s67
  s_xor_b32 s67, s67, 4096
  s_add_u32 s69, s66, s67
  v_lshlrev_b32 v23, 7, v23
  v_add_u32 v24, 0, v3
  v_xor_b32 v24, v24, v22
  v_lshl_add_u32 v24, v24, 4, v23
  v_add_u32 v4, s68, v24
  v_add_u32 v5, s69, v24
  v_add_u32 v24, 4, v3
  v_xor_b32 v24, v24, v22
  v_lshl_add_u32 v24, v24, 4, v23
  v_add_u32 v6, s68, v24
  v_add_u32 v7, s69, v24
  v_bfe_u32 v22, v1, 2, 2
  v_lshl_add_u32 v22, v3, 3, v22
  v_and_b32 v24, 3, v1
  v_mul_u32_u24 v8, 320, v22
  v_and_b32 v25, 1, v3
  v_lshl_add_u32 v8, v25, 5, v8
  v_lshrrev_b32 v25, 1, v3
  v_lshl_add_u32 v8, v25, 6, v8
  v_mul_u32_u24 v25, 40, v24
  v_lshlrev_b32 v26, 3, v24
  v_cndmask_b32 v25, v25, v26, s[64:65]
  s_mul_i32 s66, s62, 160
  s_add_u32 s66, s66, 16384
  v_add3_u32 v8, v8, v25, s66
  v_mul_u32_u24 v9, 40, v22
  s_lshl_b32 s66, s62, 5
  s_add_u32 s66, s66, 37120
  v_add3_u32 v9, v9, v26, s66
  v_mov_b32 v72, 0
  v_mov_b32 v73, 0
  v_mov_b32 v74, 0
  v_mov_b32 v75, 0
  v_mov_b32 v76, 0
  v_mov_b32 v77, 0
  v_mov_b32 v78, 0
  v_mov_b32 v79, 0
  v_mov_b32 v80, 0
  v_mov_b32 v81, 0
  v_mov_b32 v82, 0
  v_mov_b32 v83, 0
  v_mov_b32 v84, 0
  v_mov_b32 v85, 0
  v_mov_b32 v86, 0
  v_mov_b32 v87, 0
  v_mov_b32 v88, 0
  v_mov_b32 v89, 0
  v_mov_b32 v90, 0
  v_mov_b32 v91, 0
  v_mov_b32 v92, 0
  v_mov_b32 v93, 0
  v_mov_b32 v94, 0
  v_mov_b32 v95, 0
  v_mov_b32 v96, 0
  v_mov_b32 v97, 0
  v_mov_b32 v98, 0
  v_mov_b32 v99, 0
  v_mov_b32 v100, 0
  v_mov_b32 v101, 0
  v_mov_b32 v102, 0
  v_mov_b32 v103, 0
  v_mov_b32 v104, 0
  v_mov_b32 v105, 0
  v_mov_b32 v106, 0
  v_mov_b32 v107, 0
  v_mov_b32 v108, 0
  v_mov_b32 v109, 0
  v_mov_b32 v110, 0
  v_mov_b32 v111, 0
  v_mov_b32 v112, 0
  v_mov_b32 v113, 0
  v_mov_b32 v114, 0
  v_mov_b32 v115, 0
  v_mov_b32 v116, 0
  v_mov_b32 v117, 0
  v_mov_b32 v118, 0
  v_mov_b32 v119, 0
  v_mov_b32 v120, 0
  v_mov_b32 v121, 0
  v_mov_b32 v122, 0
  v_mov_b32 v123, 0
  v_mov_b32 v124, 0
  v_mov_b32 v125, 0
  v_mov_b32 v126, 0
  v_mov_b32 v127, 0
  v_mov_b32 v128, 0
  v_mov_b32 v129, 0
  v_mov_b32 v130, 0
  v_mov_b32 v131, 0
  v_mov_b32 v132, 0
  v_mov_b32 v133, 0
  v_mov_b32 v134, 0
  v_mov_b32 v135, 0
  v_mov_b32 v136, 0
  v_mov_b32 v137, 0
  v_mov_b32 v138, 0
  v_mov_b32 v139, 0
  v_mov_b32 v140, 0
  v_mov_b32 v141, 0
  v_mov_b32 v142, 0
  v_mov_b32 v143, 0
  v_mov_b32 v144, 0
  v_mov_b32 v145, 0
  v_mov_b32 v146, 0
  v_mov_b32 v147, 0
  v_mov_b32 v148, 0
  v_mov_b32 v149, 0
  v_mov_b32 v150, 0
  v_mov_b32 v151, 0
  v_mov_b32 v152, 0
  v_mov_b32 v153, 0
  v_mov_b32 v154, 0
  v_mov_b32 v155, 0
  v_mov_b32 v156, 0
  v_mov_b32 v157, 0
  v_mov_b32 v158, 0
  v_mov_b32 v159, 0
  s_sub_u32 s66, s55, 1
  s_cmp_lt_u32 s66, 2
  s_mov_b32 s70, 81920
  s_cselect_b32 s70, 163840, s70
  s_mov_b32 s71, 1280
  s_cselect_b32 s71, 2560, s71
  s_cselect_b32 s72, 5242880, 0
  s_lshl_b32 s66, s53, 3
  s_lshl_b32 s67, s57, 5
  s_add_u32 s66, s66, s67
  s_lshl_b32 s67, s62, 2
  s_add_u32 s66, s66, s67
  s_mul_i32 s66, s66, s70
  s_add_u32 s72, s72, s66
  s_lshl_b32 s66, s56, 2
  s_lshl_b32 s67, s61, 1
  s_add_u32 s66, s66, s67
  s_add_u32 s67, s66, s63
  s_xor_b32 s76, s63, 1
  s_add_u32 s66, s66, s76
  s_mul_i32 s76, s66, s71
  s_add_u32 s73, s72, s76
  s_mul_i32 s76, s67, s71
  s_add_u32 s72, s72, s76
  s_mul_i32 s74, s67, 2560
  s_add_u32 s74, s74, 10485760
  v_mul_lo_u32 v22, v3, s70
  v_lshl_add_u32 v10, v2, 4, v22
  v_lshl_add_u32 v11, v2, 3, v22
  v_add_u32 v11, 1024, v11
  v_mov_b32 v12, 0
  v_mov_b32 v13, 0
  v_mov_b32 v14, 0
  s_cmp_eq_u32 s55, 2
  s_cbranch_scc0 P1_SETUP_DONE
  s_mov_b32 s76, 0xCCCCCCCD
  v_lshrrev_b32 v25, 1, v3
  v_mul_u32_u24 v25, 640, v25
  v_and_b32 v26, 1, v3
  v_mul_u32_u24 v26, 320, v26
  v_add3_u32 v25, v25, v26, s71
  v_subrev_u32 v25, 1280, v25
  v_add_u32 v22, 0, v2
  v_mul_hi_u32 v23, v22, s76
  v_lshrrev_b32 v23, 4, v23
  v_mul_u32_u24 v24, 20, v23
  v_sub_u32 v24, v22, v24
  v_mul_lo_u32 v23, v23, s70
  v_lshl_add_u32 v23, v24, 4, v23
  v_add_u32 v10, v23, v25
  v_add_u32 v22, 16, v2
  v_mul_hi_u32 v23, v22, s76
  v_lshrrev_b32 v23, 4, v23
  v_mul_u32_u24 v24, 20, v23
  v_sub_u32 v24, v22, v24
  v_mul_lo_u32 v23, v23, s70
  v_lshl_add_u32 v23, v24, 4, v23
  v_add_u32 v11, v23, v25
  v_add_u32 v22, 32, v2
  v_mul_hi_u32 v23, v22, s76
  v_lshrrev_b32 v23, 4, v23
  v_mul_u32_u24 v24, 20, v23
  v_sub_u32 v24, v22, v24
  v_mul_lo_u32 v23, v23, s70
  v_lshl_add_u32 v23, v24, 4, v23
  v_add_u32 v12, v23, v25
  v_add_u32 v22, 48, v2
  v_mul_hi_u32 v23, v22, s76
  v_lshrrev_b32 v23, 4, v23
  v_mul_u32_u24 v24, 20, v23
  v_sub_u32 v24, v22, v24
  v_mul_lo_u32 v23, v23, s70
  v_lshl_add_u32 v23, v24, 4, v23
  v_add_u32 v13, v23, v25
  v_add_u32 v22, 64, v2
  v_mul_hi_u32 v23, v22, s76
  v_lshrrev_b32 v23, 4, v23
  v_mul_u32_u24 v24, 20, v23
  v_sub_u32 v24, v22, v24
  v_mul_lo_u32 v23, v23, s70
  v_lshl_add_u32 v23, v24, 4, v23
  v_add_u32 v14, v23, v25
P1_SETUP_DONE:
  s_mov_b32 s76, 0
  s_cmp_eq_u32 s55, 2
  s_cselect_b32 s76, 1, s76
  s_lshr_b32 s66, s53, 1
  s_add_u32 s66, s66, 2
  s_cmp_eq_u32 s57, 1
  s_cselect_b32 s76, s66, s76
  s_mov_b32 s78, 0
  s_mov_b32 s79, 39744
  s_waitcnt lgkmcnt(0)
  s_barrier
  s_cmp_eq_u32 s76, 1
  s_cbranch_scc1 P1_V1
  s_cmp_eq_u32 s76, 2
  s_cbranch_scc1 P1_V2
  s_cmp_eq_u32 s76, 3
  s_cbranch_scc1 P1_V3
P1_V0:
  ds_read_b64_tr_b16 v[48:49], v8 offset:0
  ds_read_b64_tr_b16 v[50:51], v8 offset:1280
  ds_read_b128 v[16:19], v4 offset:0
  ds_read_b128 v[20:23], v4 offset:2048
  ds_read_b128 v[24:27], v5 offset:0
  ds_read_b128 v[28:31], v5 offset:2048
  ds_read_b64_tr_b16 v[52:53], v8 offset:8
  ds_read_b64_tr_b16 v[54:55], v8 offset:1288
  ds_read_b64_tr_b16 v[56:57], v8 offset:16
  ds_read_b64_tr_b16 v[58:59], v8 offset:1296
  ds_read_b64_tr_b16 v[60:61], v8 offset:24
  ds_read_b64_tr_b16 v[62:63], v8 offset:1304
P1_L0:
  s_and_b32 s77, s78, 3
  s_cmp_eq_u32 s77, 3
  s_cselect_b32 s77, 4294848064, s79
  s_waitcnt lgkmcnt(6)
  v_mfma_f32_16x16x32_bf16 v[72:75], v[48:51], v[16:19], v[72:75]
  ds_read_b64_tr_b16 v[64:65], v8 offset:32
  ds_read_b64_tr_b16 v[66:67], v8 offset:1312
  v_mfma_f32_16x16x32_bf16 v[92:95], v[48:51], v[20:23], v[92:95]
  ds_read_b128 v[32:35], v6 offset:0
  ds_read_b128 v[36:39], v6 offset:2048
  v_mfma_f32_16x16x32_bf16 v[112:115], v[48:51], v[24:27], v[112:115]
  ds_read_b128 v[40:43], v7 offset:0
  ds_read_b128 v[44:47], v7 offset:2048
  v_mfma_f32_16x16x32_bf16 v[132:135], v[48:51], v[28:31], v[132:135]
  ds_read_b64_tr_b16 v[48:49], v8 offset:10368
  s_waitcnt lgkmcnt(11)
  v_mfma_f32_16x16x32_bf16 v[76:79], v[52:55], v[16:19], v[76:79]
  ds_read_b64_tr_b16 v[50:51], v8 offset:11648
  v_mfma_f32_16x16x32_bf16 v[96:99], v[52:55], v[20:23], v[96:99]
  v_mfma_f32_16x16x32_bf16 v[116:119], v[52:55], v[24:27], v[116:119]
  v_mfma_f32_16x16x32_bf16 v[136:139], v[52:55], v[28:31], v[136:139]
  ds_read_b64_tr_b16 v[52:53], v8 offset:10376
  s_waitcnt lgkmcnt(11)
  v_mfma_f32_16x16x32_bf16 v[80:83], v[56:59], v[16:19], v[80:83]
  ds_read_b64_tr_b16 v[54:55], v8 offset:11656
  v_mfma_f32_16x16x32_bf16 v[100:103], v[56:59], v[20:23], v[100:103]
  v_mfma_f32_16x16x32_bf16 v[120:123], v[56:59], v[24:27], v[120:123]
  v_mfma_f32_16x16x32_bf16 v[140:143], v[56:59], v[28:31], v[140:143]
  ds_read_b64_tr_b16 v[56:57], v8 offset:10384
  s_waitcnt lgkmcnt(11)
  v_mfma_f32_16x16x32_bf16 v[84:87], v[60:63], v[16:19], v[84:87]
  ds_read_b64_tr_b16 v[58:59], v8 offset:11664
  v_mfma_f32_16x16x32_bf16 v[104:107], v[60:63], v[20:23], v[104:107]
  v_mfma_f32_16x16x32_bf16 v[124:127], v[60:63], v[24:27], v[124:127]
  v_mfma_f32_16x16x32_bf16 v[144:147], v[60:63], v[28:31], v[144:147]
  ds_read_b64_tr_b16 v[60:61], v8 offset:10392
  s_waitcnt lgkmcnt(11)
  v_mfma_f32_16x16x32_bf16 v[88:91], v[64:67], v[16:19], v[88:91]
  ds_read_b64_tr_b16 v[62:63], v8 offset:11672
  v_mfma_f32_16x16x32_bf16 v[108:111], v[64:67], v[20:23], v[108:111]
  v_mfma_f32_16x16x32_bf16 v[128:131], v[64:67], v[24:27], v[128:131]
  v_mfma_f32_16x16x32_bf16 v[148:151], v[64:67], v[28:31], v[148:151]
  s_waitcnt lgkmcnt(6)
  v_mfma_f32_16x16x32_bf16 v[72:75], v[48:51], v[32:35], v[72:75]
  ds_read_b64_tr_b16 v[64:65], v8 offset:10400
  ds_read_b64_tr_b16 v[66:67], v8 offset:11680
  v_mfma_f32_16x16x32_bf16 v[92:95], v[48:51], v[36:39], v[92:95]
  v_mfma_f32_16x16x32_bf16 v[112:115], v[48:51], v[40:43], v[112:115]
  v_mfma_f32_16x16x32_bf16 v[132:135], v[48:51], v[44:47], v[132:135]
  s_waitcnt lgkmcnt(6)
  v_mfma_f32_16x16x32_bf16 v[76:79], v[52:55], v[32:35], v[76:79]
  v_mfma_f32_16x16x32_bf16 v[96:99], v[52:55], v[36:39], v[96:99]
  v_mfma_f32_16x16x32_bf16 v[116:119], v[52:55], v[40:43], v[116:119]
  v_mfma_f32_16x16x32_bf16 v[136:139], v[52:55], v[44:47], v[136:139]
  s_waitcnt lgkmcnt(0)
  s_barrier
  v_add_u32 v8, s77, v8
  v_add_u32 v4, s77, v4
  v_mfma_f32_16x16x32_bf16 v[80:83], v[56:59], v[32:35], v[80:83]
  v_add_u32 v5, s77, v5
  ds_read_b64_tr_b16 v[48:49], v8 offset:0
  v_mfma_f32_16x16x32_bf16 v[100:103], v[56:59], v[36:39], v[100:103]
  ds_read_b64_tr_b16 v[50:51], v8 offset:1280
  ds_read_b128 v[16:19], v4 offset:0
  v_mfma_f32_16x16x32_bf16 v[120:123], v[56:59], v[40:43], v[120:123]
  ds_read_b128 v[20:23], v4 offset:2048
  ds_read_b128 v[24:27], v5 offset:0
  v_mfma_f32_16x16x32_bf16 v[140:143], v[56:59], v[44:47], v[140:143]
  ds_read_b128 v[28:31], v5 offset:2048
  ds_read_b64_tr_b16 v[52:53], v8 offset:8
  v_mfma_f32_16x16x32_bf16 v[84:87], v[60:63], v[32:35], v[84:87]
  ds_read_b64_tr_b16 v[54:55], v8 offset:1288
  v_add_u32 v6, s77, v6
  v_mfma_f32_16x16x32_bf16 v[104:107], v[60:63], v[36:39], v[104:107]
  v_add_u32 v7, s77, v7
  ds_read_b64_tr_b16 v[56:57], v8 offset:16
  v_mfma_f32_16x16x32_bf16 v[124:127], v[60:63], v[40:43], v[124:127]
  ds_read_b64_tr_b16 v[58:59], v8 offset:1296
  v_mfma_f32_16x16x32_bf16 v[144:147], v[60:63], v[44:47], v[144:147]
  ds_read_b64_tr_b16 v[60:61], v8 offset:24
  v_mfma_f32_16x16x32_bf16 v[88:91], v[64:67], v[32:35], v[88:91]
  ds_read_b64_tr_b16 v[62:63], v8 offset:1304
  v_mfma_f32_16x16x32_bf16 v[108:111], v[64:67], v[36:39], v[108:111]
  v_mfma_f32_16x16x32_bf16 v[128:131], v[64:67], v[40:43], v[128:131]
  v_mfma_f32_16x16x32_bf16 v[148:151], v[64:67], v[44:47], v[148:151]
  s_add_u32 s78, s78, 1
  s_cmp_lt_u32 s78, 10
  s_cbranch_scc1 P1_L0
  s_branch P1_EPI_QK
P1_V1:
  ds_read_b64_tr_b16 v[48:49], v8 offset:0
  ds_read_b64_tr_b16 v[50:51], v8 offset:1280
  ds_read_b128 v[16:19], v4 offset:0
  ds_read_b128 v[20:23], v4 offset:512
  ds_read_b128 v[24:27], v5 offset:0
  ds_read_b128 v[28:31], v5 offset:512
  ds_read_b64_tr_b16 v[52:53], v8 offset:32
  ds_read_b64_tr_b16 v[54:55], v8 offset:1312
  ds_read_b64_tr_b16 v[56:57], v8 offset:64
  ds_read_b64_tr_b16 v[58:59], v8 offset:1344
  ds_read_b64_tr_b16 v[60:61], v8 offset:96
  ds_read_b64_tr_b16 v[62:63], v8 offset:1376
P1_L1:
  s_and_b32 s77, s78, 3
  s_cmp_eq_u32 s77, 3
  s_cselect_b32 s77, 4294848064, s79
  s_waitcnt lgkmcnt(6)
  v_mfma_f32_16x16x32_bf16 v[72:75], v[16:19], v[48:51], v[72:75]
  ds_read_b64_tr_b16 v[64:65], v8 offset:128
  ds_read_b64_tr_b16 v[66:67], v8 offset:1408
  v_mfma_f32_16x16x32_bf16 v[92:95], v[20:23], v[48:51], v[92:95]
  ds_read_b128 v[32:35], v6 offset:0
  ds_read_b128 v[36:39], v6 offset:512
  v_mfma_f32_16x16x32_bf16 v[112:115], v[24:27], v[48:51], v[112:115]
  ds_read_b128 v[40:43], v7 offset:0
  ds_read_b128 v[44:47], v7 offset:512
  v_mfma_f32_16x16x32_bf16 v[132:135], v[28:31], v[48:51], v[132:135]
  ds_read_b64_tr_b16 v[48:49], v8 offset:10368
  s_waitcnt lgkmcnt(11)
  v_mfma_f32_16x16x32_bf16 v[76:79], v[16:19], v[52:55], v[76:79]
  ds_read_b64_tr_b16 v[50:51], v8 offset:11648
  v_mfma_f32_16x16x32_bf16 v[96:99], v[20:23], v[52:55], v[96:99]
  v_mfma_f32_16x16x32_bf16 v[116:119], v[24:27], v[52:55], v[116:119]
  v_mfma_f32_16x16x32_bf16 v[136:139], v[28:31], v[52:55], v[136:139]
  ds_read_b64_tr_b16 v[52:53], v8 offset:10400
  s_waitcnt lgkmcnt(11)
  v_mfma_f32_16x16x32_bf16 v[80:83], v[16:19], v[56:59], v[80:83]
  ds_read_b64_tr_b16 v[54:55], v8 offset:11680
  v_mfma_f32_16x16x32_bf16 v[100:103], v[20:23], v[56:59], v[100:103]
  v_mfma_f32_16x16x32_bf16 v[120:123], v[24:27], v[56:59], v[120:123]
  v_mfma_f32_16x16x32_bf16 v[140:143], v[28:31], v[56:59], v[140:143]
  ds_read_b64_tr_b16 v[56:57], v8 offset:10432
  s_waitcnt lgkmcnt(11)
  v_mfma_f32_16x16x32_bf16 v[84:87], v[16:19], v[60:63], v[84:87]
  ds_read_b64_tr_b16 v[58:59], v8 offset:11712
  v_mfma_f32_16x16x32_bf16 v[104:107], v[20:23], v[60:63], v[104:107]
  v_mfma_f32_16x16x32_bf16 v[124:127], v[24:27], v[60:63], v[124:127]
  v_mfma_f32_16x16x32_bf16 v[144:147], v[28:31], v[60:63], v[144:147]
  ds_read_b64_tr_b16 v[60:61], v8 offset:10464
  s_waitcnt lgkmcnt(11)
  v_mfma_f32_16x16x32_bf16 v[88:91], v[16:19], v[64:67], v[88:91]
  ds_read_b64_tr_b16 v[62:63], v8 offset:11744
  v_mfma_f32_16x16x32_bf16 v[108:111], v[20:23], v[64:67], v[108:111]
  v_mfma_f32_16x16x32_bf16 v[128:131], v[24:27], v[64:67], v[128:131]
  v_mfma_f32_16x16x32_bf16 v[148:151], v[28:31], v[64:67], v[148:151]
  s_waitcnt lgkmcnt(6)
  v_mfma_f32_16x16x32_bf16 v[72:75], v[32:35], v[48:51], v[72:75]
  ds_read_b64_tr_b16 v[64:65], v8 offset:10496
  ds_read_b64_tr_b16 v[66:67], v8 offset:11776
  v_mfma_f32_16x16x32_bf16 v[92:95], v[36:39], v[48:51], v[92:95]
  v_mfma_f32_16x16x32_bf16 v[112:115], v[40:43], v[48:51], v[112:115]
  v_mfma_f32_16x16x32_bf16 v[132:135], v[44:47], v[48:51], v[132:135]
  s_waitcnt lgkmcnt(6)
  v_mfma_f32_16x16x32_bf16 v[76:79], v[32:35], v[52:55], v[76:79]
  v_mfma_f32_16x16x32_bf16 v[96:99], v[36:39], v[52:55], v[96:99]
  v_mfma_f32_16x16x32_bf16 v[116:119], v[40:43], v[52:55], v[116:119]
  v_mfma_f32_16x16x32_bf16 v[136:139], v[44:47], v[52:55], v[136:139]
  s_waitcnt lgkmcnt(0)
  s_barrier
  v_add_u32 v8, s77, v8
  v_add_u32 v4, s77, v4
  v_mfma_f32_16x16x32_bf16 v[80:83], v[32:35], v[56:59], v[80:83]
  v_add_u32 v5, s77, v5
  ds_read_b64_tr_b16 v[48:49], v8 offset:0
  v_mfma_f32_16x16x32_bf16 v[100:103], v[36:39], v[56:59], v[100:103]
  ds_read_b64_tr_b16 v[50:51], v8 offset:1280
  ds_read_b128 v[16:19], v4 offset:0
  v_mfma_f32_16x16x32_bf16 v[120:123], v[40:43], v[56:59], v[120:123]
  ds_read_b128 v[20:23], v4 offset:512
  ds_read_b128 v[24:27], v5 offset:0
  v_mfma_f32_16x16x32_bf16 v[140:143], v[44:47], v[56:59], v[140:143]
  ds_read_b128 v[28:31], v5 offset:512
  ds_read_b64_tr_b16 v[52:53], v8 offset:32
  v_mfma_f32_16x16x32_bf16 v[84:87], v[32:35], v[60:63], v[84:87]
  ds_read_b64_tr_b16 v[54:55], v8 offset:1312
  v_add_u32 v6, s77, v6
  v_mfma_f32_16x16x32_bf16 v[104:107], v[36:39], v[60:63], v[104:107]
  v_add_u32 v7, s77, v7
  ds_read_b64_tr_b16 v[56:57], v8 offset:64
  v_mfma_f32_16x16x32_bf16 v[124:127], v[40:43], v[60:63], v[124:127]
  ds_read_b64_tr_b16 v[58:59], v8 offset:1344
  v_mfma_f32_16x16x32_bf16 v[144:147], v[44:47], v[60:63], v[144:147]
  ds_read_b64_tr_b16 v[60:61], v8 offset:96
  v_mfma_f32_16x16x32_bf16 v[88:91], v[32:35], v[64:67], v[88:91]
  ds_read_b64_tr_b16 v[62:63], v8 offset:1376
  v_mfma_f32_16x16x32_bf16 v[108:111], v[36:39], v[64:67], v[108:111]
  v_mfma_f32_16x16x32_bf16 v[128:131], v[40:43], v[64:67], v[128:131]
  v_mfma_f32_16x16x32_bf16 v[148:151], v[44:47], v[64:67], v[148:151]
  s_add_u32 s78, s78, 1
  s_cmp_lt_u32 s78, 10
  s_cbranch_scc1 P1_L1
  s_branch P1_EPI_V
P1_V2:
  ds_read_b64_tr_b16 v[48:49], v8 offset:0
  ds_read_b64_tr_b16 v[50:51], v8 offset:1280
  ds_read_b128 v[16:19], v4 offset:0
  ds_read_b128 v[20:23], v4 offset:2048
  ds_read_b128 v[24:27], v5 offset:0
  ds_read_b128 v[28:31], v5 offset:2048
  ds_read_b64_tr_b16 v[52:53], v8 offset:8
  ds_read_b64_tr_b16 v[54:55], v8 offset:1288
  ds_read_b64_tr_b16 v[56:57], v8 offset:16
  ds_read_b64_tr_b16 v[58:59], v8 offset:1296
  ds_read_b64_tr_b16 v[60:61], v8 offset:24
  ds_read_b64_tr_b16 v[62:63], v8 offset:1304
  ds_read_b64_tr_b16 v[64:65], v8 offset:32
  ds_read_b64_tr_b16 v[66:67], v8 offset:1312
P1_L2:
  s_and_b32 s77, s78, 3
  s_cmp_eq_u32 s77, 3
  s_cselect_b32 s77, 4294848064, s79
  s_waitcnt lgkmcnt(8)
  v_mfma_f32_16x16x32_bf16 v[72:75], v[48:51], v[16:19], v[72:75]
  ds_read_b64_tr_b16 v[68:69], v9 offset:0
  ds_read_b64_tr_b16 v[70:71], v9 offset:160
  v_mfma_f32_16x16x32_bf16 v[92:95], v[48:51], v[20:23], v[92:95]
  ds_read_b128 v[32:35], v6 offset:0
  ds_read_b128 v[36:39], v6 offset:2048
  v_mfma_f32_16x16x32_bf16 v[112:115], v[48:51], v[24:27], v[112:115]
  ds_read_b128 v[40:43], v7 offset:0
  ds_read_b128 v[44:47], v7 offset:2048
  v_mfma_f32_16x16x32_bf16 v[132:135], v[48:51], v[28:31], v[132:135]
  ds_read_b64_tr_b16 v[48:49], v8 offset:10368
  s_waitcnt lgkmcnt(13)
  v_mfma_f32_16x16x32_bf16 v[76:79], v[52:55], v[16:19], v[76:79]
  ds_read_b64_tr_b16 v[50:51], v8 offset:11648
  v_mfma_f32_16x16x32_bf16 v[96:99], v[52:55], v[20:23], v[96:99]
  v_mfma_f32_16x16x32_bf16 v[116:119], v[52:55], v[24:27], v[116:119]
  v_mfma_f32_16x16x32_bf16 v[136:139], v[52:55], v[28:31], v[136:139]
  ds_read_b64_tr_b16 v[52:53], v8 offset:10376
  s_waitcnt lgkmcnt(13)
  v_mfma_f32_16x16x32_bf16 v[80:83], v[56:59], v[16:19], v[80:83]
  ds_read_b64_tr_b16 v[54:55], v8 offset:11656
  v_mfma_f32_16x16x32_bf16 v[100:103], v[56:59], v[20:23], v[100:103]
  v_mfma_f32_16x16x32_bf16 v[120:123], v[56:59], v[24:27], v[120:123]
  v_mfma_f32_16x16x32_bf16 v[140:143], v[56:59], v[28:31], v[140:143]
  ds_read_b64_tr_b16 v[56:57], v8 offset:10384
  s_waitcnt lgkmcnt(13)
  v_mfma_f32_16x16x32_bf16 v[84:87], v[60:63], v[16:19], v[84:87]
  ds_read_b64_tr_b16 v[58:59], v8 offset:11664
  v_mfma_f32_16x16x32_bf16 v[104:107], v[60:63], v[20:23], v[104:107]
  v_mfma_f32_16x16x32_bf16 v[124:127], v[60:63], v[24:27], v[124:127]
  v_mfma_f32_16x16x32_bf16 v[144:147], v[60:63], v[28:31], v[144:147]
  ds_read_b64_tr_b16 v[60:61], v8 offset:10392
  s_waitcnt lgkmcnt(13)
  v_mfma_f32_16x16x32_bf16 v[88:91], v[64:67], v[16:19], v[88:91]
  ds_read_b64_tr_b16 v[62:63], v8 offset:11672
  v_mfma_f32_16x16x32_bf16 v[108:111], v[64:67], v[20:23], v[108:111]
  v_mfma_f32_16x16x32_bf16 v[128:131], v[64:67], v[24:27], v[128:131]
  v_mfma_f32_16x16x32_bf16 v[148:151], v[64:67], v[28:31], v[148:151]
  ds_read_b64_tr_b16 v[64:65], v8 offset:10400
  s_waitcnt lgkmcnt(13)
  v_mfma_f32_16x16x32_bf16 v[152:155], v[68:71], v[16:19], v[152:155]
  ds_read_b64_tr_b16 v[66:67], v8 offset:11680
  v_mfma_f32_16x16x32_bf16 v[156:159], v[68:71], v[20:23], v[156:159]
  s_waitcnt lgkmcnt(8)
  v_mfma_f32_16x16x32_bf16 v[72:75], v[48:51], v[32:35], v[72:75]
  ds_read_b64_tr_b16 v[68:69], v9 offset:1280
  ds_read_b64_tr_b16 v[70:71], v9 offset:1440
  v_mfma_f32_16x16x32_bf16 v[92:95], v[48:51], v[36:39], v[92:95]
  v_mfma_f32_16x16x32_bf16 v[112:115], v[48:51], v[40:43], v[112:115]
  v_mfma_f32_16x16x32_bf16 v[132:135], v[48:51], v[44:47], v[132:135]
  s_waitcnt lgkmcnt(8)
  v_mfma_f32_16x16x32_bf16 v[76:79], v[52:55], v[32:35], v[76:79]
  v_mfma_f32_16x16x32_bf16 v[96:99], v[52:55], v[36:39], v[96:99]
  v_mfma_f32_16x16x32_bf16 v[116:119], v[52:55], v[40:43], v[116:119]
  v_mfma_f32_16x16x32_bf16 v[136:139], v[52:55], v[44:47], v[136:139]
  s_waitcnt lgkmcnt(0)
  s_barrier
  v_add_u32 v8, s77, v8
  v_add_u32 v4, s77, v4
  v_mfma_f32_16x16x32_bf16 v[80:83], v[56:59], v[32:35], v[80:83]
  v_add_u32 v5, s77, v5
  ds_read_b64_tr_b16 v[48:49], v8 offset:0
  v_mfma_f32_16x16x32_bf16 v[100:103], v[56:59], v[36:39], v[100:103]
  ds_read_b64_tr_b16 v[50:51], v8 offset:1280
  ds_read_b128 v[16:19], v4 offset:0
  v_mfma_f32_16x16x32_bf16 v[120:123], v[56:59], v[40:43], v[120:123]
  ds_read_b128 v[20:23], v4 offset:2048
  ds_read_b128 v[24:27], v5 offset:0
  v_mfma_f32_16x16x32_bf16 v[140:143], v[56:59], v[44:47], v[140:143]
  ds_read_b128 v[28:31], v5 offset:2048
  ds_read_b64_tr_b16 v[52:53], v8 offset:8
  v_mfma_f32_16x16x32_bf16 v[84:87], v[60:63], v[32:35], v[84:87]
  ds_read_b64_tr_b16 v[54:55], v8 offset:1288
  v_add_u32 v6, s77, v6
  v_mfma_f32_16x16x32_bf16 v[104:107], v[60:63], v[36:39], v[104:107]
  v_add_u32 v7, s77, v7
  v_add_u32 v9, s77, v9
  v_mfma_f32_16x16x32_bf16 v[124:127], v[60:63], v[40:43], v[124:127]
  ds_read_b64_tr_b16 v[56:57], v8 offset:16
  ds_read_b64_tr_b16 v[58:59], v8 offset:1296
  v_mfma_f32_16x16x32_bf16 v[144:147], v[60:63], v[44:47], v[144:147]
  ds_read_b64_tr_b16 v[60:61], v8 offset:24
  v_mfma_f32_16x16x32_bf16 v[88:91], v[64:67], v[32:35], v[88:91]
  ds_read_b64_tr_b16 v[62:63], v8 offset:1304
  v_mfma_f32_16x16x32_bf16 v[108:111], v[64:67], v[36:39], v[108:111]
  v_mfma_f32_16x16x32_bf16 v[128:131], v[64:67], v[40:43], v[128:131]
  v_mfma_f32_16x16x32_bf16 v[148:151], v[64:67], v[44:47], v[148:151]
  ds_read_b64_tr_b16 v[64:65], v8 offset:32
  v_mfma_f32_16x16x32_bf16 v[152:155], v[68:71], v[32:35], v[152:155]
  ds_read_b64_tr_b16 v[66:67], v8 offset:1312
  v_mfma_f32_16x16x32_bf16 v[156:159], v[68:71], v[36:39], v[156:159]
  s_add_u32 s78, s78, 1
  s_cmp_lt_u32 s78, 10
  s_cbranch_scc1 P1_L2
  s_branch P1_EPI_QK
P1_V3:
  ds_read_b64_tr_b16 v[48:49], v8 offset:0
  ds_read_b64_tr_b16 v[50:51], v8 offset:1280
  ds_read_b128 v[16:19], v4 offset:0
  ds_read_b128 v[20:23], v4 offset:2048
  ds_read_b128 v[24:27], v5 offset:0
  ds_read_b128 v[28:31], v5 offset:2048
  ds_read_b64_tr_b16 v[52:53], v8 offset:8
  ds_read_b64_tr_b16 v[54:55], v8 offset:1288
  ds_read_b64_tr_b16 v[56:57], v8 offset:16
  ds_read_b64_tr_b16 v[58:59], v8 offset:1296
  ds_read_b64_tr_b16 v[60:61], v8 offset:24
  ds_read_b64_tr_b16 v[62:63], v8 offset:1304
  ds_read_b64_tr_b16 v[64:65], v8 offset:32
  ds_read_b64_tr_b16 v[66:67], v8 offset:1312
P1_L3:
  s_and_b32 s77, s78, 3
  s_cmp_eq_u32 s77, 3
  s_cselect_b32 s77, 4294848064, s79
  s_waitcnt lgkmcnt(8)
  v_mfma_f32_16x16x32_bf16 v[72:75], v[48:51], v[16:19], v[72:75]
  ds_read_b64_tr_b16 v[68:69], v9 offset:0
  ds_read_b64_tr_b16 v[70:71], v9 offset:160
  v_mfma_f32_16x16x32_bf16 v[92:95], v[48:51], v[20:23], v[92:95]
  ds_read_b128 v[32:35], v6 offset:0
  ds_read_b128 v[36:39], v6 offset:2048
  v_mfma_f32_16x16x32_bf16 v[112:115], v[48:51], v[24:27], v[112:115]
  ds_read_b128 v[40:43], v7 offset:0
  ds_read_b128 v[44:47], v7 offset:2048
  v_mfma_f32_16x16x32_bf16 v[132:135], v[48:51], v[28:31], v[132:135]
  ds_read_b64_tr_b16 v[48:49], v8 offset:10368
  s_waitcnt lgkmcnt(13)
  v_mfma_f32_16x16x32_bf16 v[76:79], v[52:55], v[16:19], v[76:79]
  ds_read_b64_tr_b16 v[50:51], v8 offset:11648
  v_mfma_f32_16x16x32_bf16 v[96:99], v[52:55], v[20:23], v[96:99]
  v_mfma_f32_16x16x32_bf16 v[116:119], v[52:55], v[24:27], v[116:119]
  v_mfma_f32_16x16x32_bf16 v[136:139], v[52:55], v[28:31], v[136:139]
  ds_read_b64_tr_b16 v[52:53], v8 offset:10376
  s_waitcnt lgkmcnt(13)
  v_mfma_f32_16x16x32_bf16 v[80:83], v[56:59], v[16:19], v[80:83]
  ds_read_b64_tr_b16 v[54:55], v8 offset:11656
  v_mfma_f32_16x16x32_bf16 v[100:103], v[56:59], v[20:23], v[100:103]
  v_mfma_f32_16x16x32_bf16 v[120:123], v[56:59], v[24:27], v[120:123]
  v_mfma_f32_16x16x32_bf16 v[140:143], v[56:59], v[28:31], v[140:143]
  ds_read_b64_tr_b16 v[56:57], v8 offset:10384
  s_waitcnt lgkmcnt(13)
  v_mfma_f32_16x16x32_bf16 v[84:87], v[60:63], v[16:19], v[84:87]
  ds_read_b64_tr_b16 v[58:59], v8 offset:11664
  v_mfma_f32_16x16x32_bf16 v[104:107], v[60:63], v[20:23], v[104:107]
  v_mfma_f32_16x16x32_bf16 v[124:127], v[60:63], v[24:27], v[124:127]
  v_mfma_f32_16x16x32_bf16 v[144:147], v[60:63], v[28:31], v[144:147]
  ds_read_b64_tr_b16 v[60:61], v8 offset:10392
  s_waitcnt lgkmcnt(13)
  v_mfma_f32_16x16x32_bf16 v[88:91], v[64:67], v[16:19], v[88:91]
  ds_read_b64_tr_b16 v[62:63], v8 offset:11672
  v_mfma_f32_16x16x32_bf16 v[108:111], v[64:67], v[20:23], v[108:111]
  v_mfma_f32_16x16x32_bf16 v[128:131], v[64:67], v[24:27], v[128:131]
  v_mfma_f32_16x16x32_bf16 v[148:151], v[64:67], v[28:31], v[148:151]
  ds_read_b64_tr_b16 v[64:65], v8 offset:10400
  s_waitcnt lgkmcnt(13)
  v_mfma_f32_16x16x32_bf16 v[152:155], v[16:19], v[68:71], v[152:155]
  ds_read_b64_tr_b16 v[66:67], v8 offset:11680
  v_mfma_f32_16x16x32_bf16 v[156:159], v[20:23], v[68:71], v[156:159]
  s_waitcnt lgkmcnt(8)
  v_mfma_f32_16x16x32_bf16 v[72:75], v[48:51], v[32:35], v[72:75]
  ds_read_b64_tr_b16 v[68:69], v9 offset:1280
  ds_read_b64_tr_b16 v[70:71], v9 offset:1440
  v_mfma_f32_16x16x32_bf16 v[92:95], v[48:51], v[36:39], v[92:95]
  v_mfma_f32_16x16x32_bf16 v[112:115], v[48:51], v[40:43], v[112:115]
  v_mfma_f32_16x16x32_bf16 v[132:135], v[48:51], v[44:47], v[132:135]
  s_waitcnt lgkmcnt(8)
  v_mfma_f32_16x16x32_bf16 v[76:79], v[52:55], v[32:35], v[76:79]
  v_mfma_f32_16x16x32_bf16 v[96:99], v[52:55], v[36:39], v[96:99]
  v_mfma_f32_16x16x32_bf16 v[116:119], v[52:55], v[40:43], v[116:119]
  v_mfma_f32_16x16x32_bf16 v[136:139], v[52:55], v[44:47], v[136:139]
  s_waitcnt lgkmcnt(0)
  s_barrier
  v_add_u32 v8, s77, v8
  v_add_u32 v4, s77, v4
  v_mfma_f32_16x16x32_bf16 v[80:83], v[56:59], v[32:35], v[80:83]
  v_add_u32 v5, s77, v5
  ds_read_b64_tr_b16 v[48:49], v8 offset:0
  v_mfma_f32_16x16x32_bf16 v[100:103], v[56:59], v[36:39], v[100:103]
  ds_read_b64_tr_b16 v[50:51], v8 offset:1280
  ds_read_b128 v[16:19], v4 offset:0
  v_mfma_f32_16x16x32_bf16 v[120:123], v[56:59], v[40:43], v[120:123]
  ds_read_b128 v[20:23], v4 offset:2048
  ds_read_b128 v[24:27], v5 offset:0
  v_mfma_f32_16x16x32_bf16 v[140:143], v[56:59], v[44:47], v[140:143]
  ds_read_b128 v[28:31], v5 offset:2048
  ds_read_b64_tr_b16 v[52:53], v8 offset:8
  v_mfma_f32_16x16x32_bf16 v[84:87], v[60:63], v[32:35], v[84:87]
  ds_read_b64_tr_b16 v[54:55], v8 offset:1288
  v_add_u32 v6, s77, v6
  v_mfma_f32_16x16x32_bf16 v[104:107], v[60:63], v[36:39], v[104:107]
  v_add_u32 v7, s77, v7
  v_add_u32 v9, s77, v9
  v_mfma_f32_16x16x32_bf16 v[124:127], v[60:63], v[40:43], v[124:127]
  ds_read_b64_tr_b16 v[56:57], v8 offset:16
  ds_read_b64_tr_b16 v[58:59], v8 offset:1296
  v_mfma_f32_16x16x32_bf16 v[144:147], v[60:63], v[44:47], v[144:147]
  ds_read_b64_tr_b16 v[60:61], v8 offset:24
  v_mfma_f32_16x16x32_bf16 v[88:91], v[64:67], v[32:35], v[88:91]
  ds_read_b64_tr_b16 v[62:63], v8 offset:1304
  v_mfma_f32_16x16x32_bf16 v[108:111], v[64:67], v[36:39], v[108:111]
  v_mfma_f32_16x16x32_bf16 v[128:131], v[64:67], v[40:43], v[128:131]
  v_mfma_f32_16x16x32_bf16 v[148:151], v[64:67], v[44:47], v[148:151]
  ds_read_b64_tr_b16 v[64:65], v8 offset:32
  v_mfma_f32_16x16x32_bf16 v[152:155], v[32:35], v[68:71], v[152:155]
  ds_read_b64_tr_b16 v[66:67], v8 offset:1312
  v_mfma_f32_16x16x32_bf16 v[156:159], v[36:39], v[68:71], v[156:159]
  s_add_u32 s78, s78, 1
  s_cmp_lt_u32 s78, 10
  s_cbranch_scc1 P1_L3
P1_EPI_QK:
  s_nop 7
  s_waitcnt lgkmcnt(0)
  s_cmp_eq_u32 s55, 1
  s_cbranch_scc1 P1_NOSCALE
  s_mov_b32 s80, 0x3ea52b5c
  s_mov_b32 s81, 0x3ea52b5c
  v_pk_mul_f32 v[72:73], s[80:81], v[72:73]
  v_pk_mul_f32 v[74:75], s[80:81], v[74:75]
  v_pk_mul_f32 v[76:77], s[80:81], v[76:77]
  v_pk_mul_f32 v[78:79], s[80:81], v[78:79]
  v_pk_mul_f32 v[80:81], s[80:81], v[80:81]
  v_pk_mul_f32 v[82:83], s[80:81], v[82:83]
  v_pk_mul_f32 v[84:85], s[80:81], v[84:85]
  v_pk_mul_f32 v[86:87], s[80:81], v[86:87]
  v_pk_mul_f32 v[88:89], s[80:81], v[88:89]
  v_pk_mul_f32 v[90:91], s[80:81], v[90:91]
  v_pk_mul_f32 v[92:93], s[80:81], v[92:93]
  v_pk_mul_f32 v[94:95], s[80:81], v[94:95]
  v_pk_mul_f32 v[96:97], s[80:81], v[96:97]
  v_pk_mul_f32 v[98:99], s[80:81], v[98:99]
  v_pk_mul_f32 v[100:101], s[80:81], v[100:101]
  v_pk_mul_f32 v[102:103], s[80:81], v[102:103]
  v_pk_mul_f32 v[104:105], s[80:81], v[104:105]
  v_pk_mul_f32 v[106:107], s[80:81], v[106:107]
  v_pk_mul_f32 v[108:109], s[80:81], v[108:109]
  v_pk_mul_f32 v[110:111], s[80:81], v[110:111]
  v_pk_mul_f32 v[112:113], s[80:81], v[112:113]
  v_pk_mul_f32 v[114:115], s[80:81], v[114:115]
  v_pk_mul_f32 v[116:117], s[80:81], v[116:117]
  v_pk_mul_f32 v[118:119], s[80:81], v[118:119]
  v_pk_mul_f32 v[120:121], s[80:81], v[120:121]
  v_pk_mul_f32 v[122:123], s[80:81], v[122:123]
  v_pk_mul_f32 v[124:125], s[80:81], v[124:125]
  v_pk_mul_f32 v[126:127], s[80:81], v[126:127]
  v_pk_mul_f32 v[128:129], s[80:81], v[128:129]
  v_pk_mul_f32 v[130:131], s[80:81], v[130:131]
  v_pk_mul_f32 v[132:133], s[80:81], v[132:133]
  v_pk_mul_f32 v[134:135], s[80:81], v[134:135]
  v_pk_mul_f32 v[136:137], s[80:81], v[136:137]
  v_pk_mul_f32 v[138:139], s[80:81], v[138:139]
  v_pk_mul_f32 v[140:141], s[80:81], v[140:141]
  v_pk_mul_f32 v[142:143], s[80:81], v[142:143]
  v_pk_mul_f32 v[144:145], s[80:81], v[144:145]
  v_pk_mul_f32 v[146:147], s[80:81], v[146:147]
  v_pk_mul_f32 v[148:149], s[80:81], v[148:149]
  v_pk_mul_f32 v[150:151], s[80:81], v[150:151]
P1_NOSCALE:
  v_cvt_pk_bf16_f32 v16, v72, v73
  v_cvt_pk_bf16_f32 v17, v74, v75
  v_cvt_pk_bf16_f32 v18, v76, v77
  v_cvt_pk_bf16_f32 v19, v78, v79
  v_cvt_pk_bf16_f32 v20, v80, v81
  v_cvt_pk_bf16_f32 v21, v82, v83
  v_cvt_pk_bf16_f32 v22, v84, v85
  v_cvt_pk_bf16_f32 v23, v86, v87
  v_cvt_pk_bf16_f32 v24, v88, v89
  v_cvt_pk_bf16_f32 v25, v90, v91
  buffer_store_dwordx4 v[16:19], v10, s[8:11], s72 offen offset:0 sc1
  buffer_store_dwordx4 v[20:23], v10, s[8:11], s72 offen offset:512 sc1
  buffer_store_dwordx2 v[24:25], v11, s[8:11], s72 offen offset:0 sc1
  v_cvt_pk_bf16_f32 v28, v92, v93
  v_cvt_pk_bf16_f32 v29, v94, v95
  v_cvt_pk_bf16_f32 v30, v96, v97
  v_cvt_pk_bf16_f32 v31, v98, v99
  v_cvt_pk_bf16_f32 v32, v100, v101
  v_cvt_pk_bf16_f32 v33, v102, v103
  v_cvt_pk_bf16_f32 v34, v104, v105
  v_cvt_pk_bf16_f32 v35, v106, v107
  v_cvt_pk_bf16_f32 v36, v108, v109
  v_cvt_pk_bf16_f32 v37, v110, v111
  buffer_store_dwordx4 v[28:31], v10, s[8:11], s72 offen offset:256 sc1
  buffer_store_dwordx4 v[32:35], v10, s[8:11], s72 offen offset:768 sc1
  buffer_store_dwordx2 v[36:37], v11, s[8:11], s72 offen offset:128 sc1
  v_cvt_pk_bf16_f32 v40, v112, v113
  v_cvt_pk_bf16_f32 v41, v114, v115
  v_cvt_pk_bf16_f32 v42, v116, v117
  v_cvt_pk_bf16_f32 v43, v118, v119
  v_cvt_pk_bf16_f32 v44, v120, v121
  v_cvt_pk_bf16_f32 v45, v122, v123
  v_cvt_pk_bf16_f32 v46, v124, v125
  v_cvt_pk_bf16_f32 v47, v126, v127
  v_cvt_pk_bf16_f32 v48, v128, v129
  v_cvt_pk_bf16_f32 v49, v130, v131
  buffer_store_dwordx4 v[40:43], v10, s[8:11], s73 offen offset:0 sc1
  buffer_store_dwordx4 v[44:47], v10, s[8:11], s73 offen offset:512 sc1
  buffer_store_dwordx2 v[48:49], v11, s[8:11], s73 offen offset:0 sc1
  v_cvt_pk_bf16_f32 v52, v132, v133
  v_cvt_pk_bf16_f32 v53, v134, v135
  v_cvt_pk_bf16_f32 v54, v136, v137
  v_cvt_pk_bf16_f32 v55, v138, v139
  v_cvt_pk_bf16_f32 v56, v140, v141
  v_cvt_pk_bf16_f32 v57, v142, v143
  v_cvt_pk_bf16_f32 v58, v144, v145
  v_cvt_pk_bf16_f32 v59, v146, v147
  v_cvt_pk_bf16_f32 v60, v148, v149
  v_cvt_pk_bf16_f32 v61, v150, v151
  buffer_store_dwordx4 v[52:55], v10, s[8:11], s73 offen offset:256 sc1
  buffer_store_dwordx4 v[56:59], v10, s[8:11], s73 offen offset:768 sc1
  buffer_store_dwordx2 v[60:61], v11, s[8:11], s73 offen offset:128 sc1
  s_cmp_lt_u32 s76, 2
  s_cbranch_scc1 P1_DONE
  v_cvt_pk_bf16_f32 v64, v152, v153
  v_cvt_pk_bf16_f32 v65, v154, v155
  v_cvt_pk_bf16_f32 v66, v156, v157
  v_cvt_pk_bf16_f32 v67, v158, v159
  v_lshrrev_b32 v68, 1, v3
  v_and_b32 v69, 1, v3
  s_cmp_eq_u32 s76, 3
  s_cbranch_scc1 P1_EPI_VX
  s_cmp_eq_u32 s62, 1
  s_cbranch_scc1 P1_EPI_KX1
  v_lshlrev_b32 v70, 9, v68
  v_lshl_add_u32 v70, v69, 3, v70
  v_lshl_add_u32 v70, v2, 4, v70
  buffer_store_dwordx2 v[64:65], v70, s[8:11], s74 offen sc1
  buffer_store_dwordx2 v[66:67], v70, s[8:11], s74 offen offset:256 sc1
  s_branch P1_DONE
P1_EPI_KX1:
  v_lshlrev_b32 v70, 3, v2
  s_mov_b32 exec_lo, 0xffff
  s_mov_b32 exec_hi, 0
  buffer_store_dwordx2 v[64:65], v70, s[8:11], s74 offen offset:1024 sc1
  buffer_store_dwordx2 v[66:67], v70, s[8:11], s74 offen offset:1152 sc1
  s_mov_b64 exec, -1
  s_branch P1_DONE
P1_EPI_VX:
  v_mul_u32_u24 v70, 320, v68
  v_lshl_add_u32 v70, v69, 3, v70
  v_lshl_add_u32 v70, v2, 4, v70
  s_lshl_b32 s66, s62, 8
  s_add_u32 s74, s74, s66
  s_cmp_eq_u32 s62, 1
  s_mov_b32 s66, 0x000f000f
  s_cselect_b32 s66, s66, -1
  s_mov_b32 exec_lo, s66
  s_mov_b32 exec_hi, s66
  buffer_store_dwordx2 v[64:65], v70, s[8:11], s74 offen offset:1280 sc1
  buffer_store_dwordx2 v[66:67], v70, s[8:11], s74 offen offset:1920 sc1
  s_mov_b64 exec, -1
  s_branch P1_DONE
P1_EPI_V:
  s_nop 7
  s_waitcnt lgkmcnt(0)
  v_cvt_pk_bf16_f32 v16, v72, v73
  v_cvt_pk_bf16_f32 v17, v74, v75
  v_cvt_pk_bf16_f32 v18, v92, v93
  v_cvt_pk_bf16_f32 v19, v94, v95
  buffer_store_dwordx4 v[16:19], v10, s[8:11], s72 offen sc1
  v_cvt_pk_bf16_f32 v20, v76, v77
  v_cvt_pk_bf16_f32 v21, v78, v79
  v_cvt_pk_bf16_f32 v22, v96, v97
  v_cvt_pk_bf16_f32 v23, v98, v99
  buffer_store_dwordx4 v[20:23], v11, s[8:11], s72 offen sc1
  v_cvt_pk_bf16_f32 v24, v80, v81
  v_cvt_pk_bf16_f32 v25, v82, v83
  v_cvt_pk_bf16_f32 v26, v100, v101
  v_cvt_pk_bf16_f32 v27, v102, v103
  buffer_store_dwordx4 v[24:27], v12, s[8:11], s72 offen sc1
  v_cvt_pk_bf16_f32 v28, v84, v85
  v_cvt_pk_bf16_f32 v29, v86, v87
  v_cvt_pk_bf16_f32 v30, v104, v105
  v_cvt_pk_bf16_f32 v31, v106, v107
  buffer_store_dwordx4 v[28:31], v13, s[8:11], s72 offen sc1
  v_cvt_pk_bf16_f32 v32, v88, v89
  v_cvt_pk_bf16_f32 v33, v90, v91
  v_cvt_pk_bf16_f32 v34, v108, v109
  v_cvt_pk_bf16_f32 v35, v110, v111
  buffer_store_dwordx4 v[32:35], v14, s[8:11], s72 offen sc1
  v_cvt_pk_bf16_f32 v36, v112, v113
  v_cvt_pk_bf16_f32 v37, v114, v115
  v_cvt_pk_bf16_f32 v38, v132, v133
  v_cvt_pk_bf16_f32 v39, v134, v135
  buffer_store_dwordx4 v[36:39], v10, s[8:11], s73 offen sc1
  v_cvt_pk_bf16_f32 v40, v116, v117
  v_cvt_pk_bf16_f32 v41, v118, v119
  v_cvt_pk_bf16_f32 v42, v136, v137
  v_cvt_pk_bf16_f32 v43, v138, v139
  buffer_store_dwordx4 v[40:43], v11, s[8:11], s73 offen sc1
  v_cvt_pk_bf16_f32 v44, v120, v121
  v_cvt_pk_bf16_f32 v45, v122, v123
  v_cvt_pk_bf16_f32 v46, v140, v141
  v_cvt_pk_bf16_f32 v47, v142, v143
  buffer_store_dwordx4 v[44:47], v12, s[8:11], s73 offen sc1
  v_cvt_pk_bf16_f32 v48, v124, v125
  v_cvt_pk_bf16_f32 v49, v126, v127
  v_cvt_pk_bf16_f32 v50, v144, v145
  v_cvt_pk_bf16_f32 v51, v146, v147
  buffer_store_dwordx4 v[48:51], v13, s[8:11], s73 offen sc1
  v_cvt_pk_bf16_f32 v52, v128, v129
  v_cvt_pk_bf16_f32 v53, v130, v131
  v_cvt_pk_bf16_f32 v54, v148, v149
  v_cvt_pk_bf16_f32 v55, v150, v151
  buffer_store_dwordx4 v[52:55], v14, s[8:11], s73 offen sc1
  s_branch P1_DONE
P1_LOADER:
  s_cmp_eq_u32 s3, 8
  s_cbranch_scc1 P1_IDLE
  s_sub_u32 s12, s3, 4
  s_lshl_b32 s61, s56, 7
  s_lshl_b32 s62, s12, 3
  s_add_u32 s61, s61, s62
  v_lshrrev_b32 v2, 3, v1
  v_add_u32 v2, s61, v2
  v_mul_u32_u24 v2, 1280, v2
  s_and_b32 s62, s12, 1
  s_lshl_b32 s62, s62, 2
  v_lshrrev_b32 v3, 4, v1
  v_add_u32 v3, s62, v3
  s_lshl_b32 s62, s12, 1
  v_bfe_u32 v11, v1, 4, 1
  v_or_b32 v11, s62, v11
  s_cmp_eq_u32 s55, 2
  s_cselect_b64 vcc, -1, 0
  s_lshl_b32 s65, s12, 10
  v_cndmask_b32 v3, v3, v11, vcc
  v_and_b32 v11, 7, v1
  v_xor_b32 v3, v3, v11
  v_lshl_add_u32 v4, v3, 4, v2
  s_mov_b32 s72, 0xCCCCCCCD
  s_lshl_b32 s63, s12, 4
  v_mul_hi_u32 v3, v1, s72
  v_lshrrev_b32 v3, 4, v3
  v_mul_u32_u24 v11, 20, v3
  v_sub_u32 v11, v1, v11
  v_add_u32 v3, s63, v3
  v_mul_lo_u32 v3, v3, s58
  v_lshl_add_u32 v3, v11, 4, v3
  v_add_u32 v5, s59, v3
  s_mul_i32 s64, s12, 640
  v_lshlrev_b32 v6, 4, v1
  v_add_u32 v6, s64, v6
  s_mul_i32 s66, s12, 5184
  s_add_u32 s66, s66, 16384
  s_add_u32 s67, s64, 37120
  s_mul_i32 s68, s58, 50
  s_mul_i32 s69, s58, 3
  s_lshl_b32 s79, s58, 1
  s_add_u32 s80, s52, s53
  s_and_b32 s80, s80, 3
  s_mul_i32 s80, s80, 10
  s_lshr_b32 s80, s80, 2
  s_mul_i32 s81, s55, 0
  s_add_u32 s80, s80, s81
  s_mul_i32 s81, s54, 0
  s_add_u32 s80, s80, s81
  s_cmp_ge_u32 s80, 10
  s_cselect_b32 s81, 10, 0
  s_sub_u32 s80, s80, s81
  s_lshl_b32 s70, s80, 7
  s_lshl_b32 s71, s58, 6
  s_mul_i32 s71, s71, s80
  s_mul_i32 s73, s80, 2560
  s_mov_b32 s74, 0
  s_mov_b32 s34, 2621440
  s_mov_b32 s35, 0x00020000
  s_mov_b32 s39, 0x00020000
  s_mov_b32 s43, 0x00020000
  s_mov_b32 s77, 0
  s_cmp_eq_u32 s57, 1
  s_mov_b32 s38, 2457600
  s_cselect_b32 s38, 819200, s38
  s_cselect_b32 s42, 25600, 0
  s_waitcnt lgkmcnt(0)
  s_cselect_b32 s32, s22, s16
  s_cselect_b32 s33, s23, s17
  s_cselect_b32 s36, s24, s18
  s_cselect_b32 s37, s25, s19
  s_cmp_lt_u32 s53, 2
  s_cselect_b32 s40, s26, s28
  s_cselect_b32 s41, s27, s29
P1_LP:
  s_add_u32 s75, s74, s65
  s_add_u32 m0, s75, 0
  s_add_u32 s76, s70, 0
  buffer_load_dwordx4 v4, s[32:35], s76 offen  lds
  s_add_u32 m0, s75, 4096
  s_add_u32 s76, s70, 40960
  buffer_load_dwordx4 v4, s[32:35], s76 offen  lds
  s_add_u32 m0, s75, 8192
  s_add_u32 s76, s70, 81920
  buffer_load_dwordx4 v4, s[32:35], s76 offen  lds
  s_add_u32 m0, s75, 12288
  s_add_u32 s76, s70, 122880
  buffer_load_dwordx4 v4, s[32:35], s76 offen  lds
  s_add_u32 s75, s74, s66
  s_add_u32 m0, s75, 0
  s_mov_b32 exec_hi, 0x0fffffff
  buffer_load_dwordx4 v5, s[36:39], s71 offen  lds
  s_add_u32 s71, s71, s69
  s_add_u32 m0, s75, 960
  s_mov_b32 exec_hi, 0x0fffffff
  buffer_load_dwordx4 v5, s[36:39], s71 offen  lds
  s_add_u32 s71, s71, s69
  s_add_u32 m0, s75, 1920
  s_mov_b32 exec_hi, 0xff
  buffer_load_dwordx4 v5, s[36:39], s71 offen  lds
  s_add_u32 s71, s71, s79
  s_add_u32 m0, s75, 2592
  s_mov_b32 exec_hi, 0x0fffffff
  buffer_load_dwordx4 v5, s[36:39], s71 offen  lds
  s_add_u32 s71, s71, s69
  s_add_u32 m0, s75, 3552
  s_mov_b32 exec_hi, 0x0fffffff
  buffer_load_dwordx4 v5, s[36:39], s71 offen  lds
  s_add_u32 s71, s71, s69
  s_add_u32 m0, s75, 4512
  s_mov_b32 exec_hi, 0xff
  buffer_load_dwordx4 v5, s[36:39], s71 offen  lds
  s_add_u32 s71, s71, s68
  s_add_u32 m0, s74, s67
  s_add_u32 s70, s70, 128
  buffer_load_dwordx4 v6, s[40:43], s73 offen lds
  s_mov_b32 exec_hi, -1
  s_add_u32 s73, s73, 2560
  s_add_u32 s74, s74, 39744
  s_cmp_eq_u32 s74, 158976
  s_cselect_b32 s74, 0, s74
  s_cmp_eq_u32 s70, 1280
  s_cselect_b32 s70, 0, s70
  s_cselect_b32 s71, 0, s71
  s_cselect_b32 s73, 0, s73
  s_add_u32 s77, s77, 1
  s_cmp_lt_u32 s77, 2
  s_cbranch_scc1 P1_LP
  s_waitcnt vmcnt(11)
  s_barrier
  s_cmp_lt_u32 s77, 10
  s_cbranch_scc1 P1_LP
  s_waitcnt vmcnt(0)
  s_barrier
  s_barrier
  s_branch P1_DONE
P1_IDLE:
  s_mov_b32 s77, 0
  s_waitcnt lgkmcnt(0)
P1_IDLE1:
  s_barrier
  s_add_u32 s77, s77, 1
  s_cmp_lt_u32 s77, 11
  s_cbranch_scc1 P1_IDLE1
P1_DONE:
  s_and_b32 s13, s2, 7
  s_lshr_b32 s14, s2, 3
  s_lshr_b32 s15, s14, 4
  s_bfe_u32 s16, s14, 0x20002
  s_lshl_b32 s17, s13, 2
  s_add_u32 s17, s17, s16
  s_and_b32 s18, s14, 3
  s_lshl_b32 s19, s15, 5
  s_add_u32 s19, s19, s17
  s_cmp_eq_u32 s15, 0
  s_cselect_b32 s21, s17, 32
  s_mul_i32 s25, s19, 81920
  s_mul_i32 s26, s18, 20480
  s_add_u32 s25, s25, s26
  s_mul_i32 s26, s3, 2560
  s_add_u32 s25, s25, s26
  s_mul_i32 s27, s21, 163840
  s_lshl_b32 s28, s3, 10
  s_add_u32 s27, s27, s28
  s_add_u32 s27, s27, 5242880
  v_lshlrev_b32 v2, 4, v1
  s_cmp_eq_u32 s3, 8
  s_cbranch_scc1 P2_LOADER
  v_and_b32 v7, 31, v1
  v_lshrrev_b32 v8, 5, v1
  v_lshlrev_b32 v4, 3, v7
  v_lshl_add_u32 v4, v8, 2, v4
  v_add_u32 v4, 1024, v4
  v_mul_u32_u24 v5, 20, v8
  v_add_u32 v5, v5, v7
  v_lshlrev_b32 v5, 4, v5
  v_add_u32 v5, 1280, v5
  v_mov_b32 v3, v2
  v_mov_b32 v6, 0xdddddddd
  v_mov_b32 v17, 0
  v_mov_b32 v19, 0
  v_mov_b32 v29, 0
  v_mov_b32 v31, 0
  v_and_b32 v9, 31, v7
  v_cmp_eq_u32 vcc, 24, v9
  v_mov_b32 v9, 0
  v_mov_b32 v10, 0x3f803f80
  s_mov_b32 s22, 0x000fffff
  s_mov_b32 s23, 0x000fffff
  s_cmp_lt_u32 s3, 4
  s_cselect_b32 s24, 0x92, 0
  v_cndmask_b32 v9, v9, v10, vcc
  v_mov_b32 v36, v9
  v_mov_b32 v37, v9
  v_mov_b32 v38, v9
  v_mov_b32 v39, v9
  v_mov_b32 v40, v9
  v_mov_b32 v41, v9
  v_mov_b32 v42, v9
  v_mov_b32 v43, v9
  v_mov_b32 v44, v9
  v_mov_b32 v45, v9
  v_mov_b32 v46, v9
  v_mov_b32 v47, v9
  v_mov_b32 v48, v9
  v_mov_b32 v49, v9
  v_mov_b32 v50, v9
  v_mov_b32 v51, v9
  v_mov_b32 v68, 0
  v_mov_b32 v69, 0
  v_mov_b32 v70, 0
  v_mov_b32 v71, 0
  v_mov_b32 v72, 0
  v_mov_b32 v73, 0
  v_mov_b32 v74, 0
  v_mov_b32 v75, 0
  v_mov_b32 v76, 0
  v_mov_b32 v77, 0
  v_mov_b32 v78, 0
  v_mov_b32 v79, 0
  v_mov_b32 v80, 0
  v_mov_b32 v81, 0
  v_mov_b32 v82, 0
  v_mov_b32 v83, 0
  v_mov_b32 v84, 0
  v_mov_b32 v85, 0
  v_mov_b32 v86, 0
  v_mov_b32 v87, 0
  v_mov_b32 v88, 0
  v_mov_b32 v89, 0
  v_mov_b32 v90, 0
  v_mov_b32 v91, 0
  v_mov_b32 v92, 0
  v_mov_b32 v93, 0
  v_mov_b32 v94, 0
  v_mov_b32 v95, 0
  v_mov_b32 v96, 0
  v_mov_b32 v97, 0
  v_mov_b32 v98, 0
  v_mov_b32 v99, 0
  v_mov_b32 v100, 0
  v_mov_b32 v101, 0
  v_mov_b32 v102, 0
  v_mov_b32 v103, 0
  v_mov_b32 v104, 0
  v_mov_b32 v105, 0
  v_mov_b32 v106, 0
  v_mov_b32 v107, 0
  v_mov_b32 v108, 0
  v_mov_b32 v109, 0
  v_mov_b32 v110, 0
  v_mov_b32 v111, 0
  v_mov_b32 v112, 0
  v_mov_b32 v113, 0
  v_mov_b32 v114, 0
  v_mov_b32 v115, 0
  s_lshr_b32 s73, s13, 2
  s_and_b32 s74, s13, 3
  s_lshl_b32 s74, s74, 2
  s_and_b32 s75, s14, 3
  s_add_u32 s74, s74, s75
  s_lshr_b32 s75, s14, 2
  s_mul_i32 s60, s73, 2621440
  s_lshl_b32 s76, s74, 3
  s_lshl_b32 s77, s3, 1
  s_add_u32 s76, s76, s77
  s_mul_i32 s76, s76, 20480
  s_add_u32 s60, s60, s76
  s_add_u32 s60, s60, 10747904
  s_add_u32 s61, s60, 20480
  s_lshl_b32 s71, s74, 7
  s_lshl_b32 s76, s3, 5
  s_add_u32 s71, s71, s76
  s_mul_i32 s71, s71, 2560
  s_mul_i32 s76, s73, 1280
  s_add_u32 s71, s71, s76
  s_mul_i32 s76, s75, 160
  s_add_u32 s71, s71, s76
  s_mul_i32 s72, s3, 5120
  s_add_u32 s72, s72, 102400
  s_add_u32 s62, s60, 4096
  s_add_u32 s63, s61, 4096
  s_add_u32 s64, s60, 8192
  s_add_u32 s65, s61, 8192
  s_add_u32 s66, s60, 12288
  s_add_u32 s67, s61, 12288
  s_add_u32 s68, s60, 16384
  s_add_u32 s69, s61, 16384
  s_cmp_lg_u32 s3, 0
  s_cbranch_scc1 H1_PRE
  s_memrealtime s[44:45]
  s_lshr_b32 s49, s17, 3
  s_lshl_b32 s49, s49, 6
  v_add_u32 v9, s49, v1
  v_and_b32 v10, 7, v1
  v_cmp_gt_u32 s[50:51], 6, v10
  v_lshrrev_b32 v10, 1, v1
  v_lshlrev_b32 v10, 3, v10
  v_and_b32 v11, 1, v1
  v_add3_u32 v10, v10, v11, 6
  s_cmp_eq_u32 s15, 0
  s_cselect_b64 vcc, -1, 0
  s_cselect_b64 s[50:51], s[50:51], -1
  v_cndmask_b32 v9, v10, v9, vcc
  v_lshlrev_b32 v9, 7, v9
  v_lshlrev_b32 v7, 4, v1
  s_lshl_b32 s48, s2, 7
  s_add_u32 s48, s48, 15990784
  s_mov_b32 s49, 15990784
  s_sub_u32 s46, s6, 1000
  s_subb_u32 s47, s7, 0
  s_waitcnt lgkmcnt(0)
  v_mov_b32 v120, s44
  v_mov_b32 v121, s45
  v_mov_b32 v122, s44
  v_mov_b32 v123, s45
  v_mov_b32 v11, s47
H1_PRE:
  s_waitcnt vmcnt(0)
  s_barrier
  s_cmp_lg_u32 s3, 0
  s_cbranch_scc1 H1_WAIT
  s_mov_b64 exec, 0xff
  buffer_store_dwordx4 v[120:123], v7, s[8:11], s48 offen sc1
  s_mov_b64 exec, -1
  s_mov_b64 exec, s[50:51]
  s_mov_b32 s48, 0
H1_POLL:
  buffer_load_dwordx2 v[124:125], v9, s[8:11], s49 offen sc1
  s_add_u32 s48, s48, 1
  s_waitcnt vmcnt(0)
  v_subrev_co_u32 v10, vcc, s46, v124
  s_nop 1
  v_subb_co_u32 v7, vcc, v125, v11, vcc
  v_lshrrev_b32 v10, 24, v10
  v_or_b32 v10, v10, v7
  v_cmp_eq_u32 vcc, 0, v10
  s_cmp_ge_u32 s48, 65536
  s_cbranch_scc1 H1_OUT
  s_nop 1
  s_cmp_eq_u64 vcc, s[50:51]
  s_cbranch_scc1 H1_OUT
  s_sleep 4
  s_branch H1_POLL
H1_OUT:
  s_mov_b64 exec, -1
H1_WAIT:
  s_mov_b32 m0, s28
  s_barrier
  buffer_load_dwordx4 v2, s[8:11], s27 offen lds
  buffer_load_dwordx4 v[12:15], v2, s[8:11], s25 offen
  buffer_load_dword v16, v4, s[8:11], s25 offen
  buffer_load_dwordx4 v[20:23], v2, s[8:11], s25 offen offset:1280
  buffer_load_dword v18, v4, s[8:11], s25 offen offset:1280
  s_setprio 2
  s_mov_b64 vcc, -1
  s_mov_b32 s20, 0
  s_add_u32 m0, m0, 8192
  s_add_u32 s27, s27, 8192
  buffer_load_dwordx4 v2, s[8:11], s27 offen lds
  s_add_u32 m0, m0, 8192
  s_add_u32 s27, s27, 8192
  buffer_load_dwordx4 v2, s[8:11], s27 offen lds
  s_add_u32 m0, m0, 8192
  s_add_u32 s27, s27, 8192
  buffer_load_dwordx4 v2, s[8:11], s27 offen lds
  s_waitcnt vmcnt(3)
  s_barrier
  ds_read_b128 v[24:27], v3
  ds_read_b32 v28, v4
  ds_read_b128 v[32:35], v3 offset:2560
  ds_read_b32 v30, v4 offset:2560
  s_mov_b64 exec, s[22:23]
  ds_read_b128 v[36:39], v5
  ds_read_b128 v[40:43], v5 offset:640
  s_mov_b64 exec, -1
  s_waitcnt lgkmcnt(4)
  v_mfma_f32_32x32x16_bf16 v[52:67], v[24:27], v[12:15], 0
  v_mfma_f32_32x32x8_bf16 v[52:67], v[28:29], v[16:17], v[52:67]
  s_nop 15
  .p2align 6
P2_LOOP:
  v_exp_f32 v52, v52
  v_exp_f32 v53, v53
  v_smfmac_f32_32x32x32_bf16 v[100:115], v[48:51], v[76:83], v6
  v_exp_f32 v54, v54
  v_exp_f32 v55, v55
  v_mfma_f32_32x32x16_bf16 v[68:83], v[24:27], v[20:23], 0
  v_exp_f32 v56, v56
  v_exp_f32 v57, v57
  v_exp_f32 v58, v58
  v_exp_f32 v59, v59
  v_mfma_f32_32x32x8_bf16 v[68:83], v[28:29], v[18:19], v[68:83]
  s_waitcnt lgkmcnt(0)
  ds_read_b128 v[24:27], v3 offset:5120
  ds_read_b32 v28, v4 offset:5120
  v_exp_f32 v60, v60
  v_exp_f32 v61, v61
  v_exp_f32 v62, v62
  v_exp_f32 v63, v63
  v_smfmac_f32_32x32x32_bf16 v[84:99], v[36:39], v[52:59], v6
  v_exp_f32 v64, v64
  v_exp_f32 v65, v65
  v_exp_f32 v66, v66
  v_exp_f32 v67, v67
  v_exp_f32 v68, v68
  v_exp_f32 v69, v69
  v_smfmac_f32_32x32x32_bf16 v[84:99], v[40:43], v[60:67], v6
  v_exp_f32 v70, v70
  v_exp_f32 v71, v71
  v_mfma_f32_32x32x16_bf16 v[52:67], v[32:35], v[12:15], 0
  v_exp_f32 v72, v72
  v_exp_f32 v73, v73
  v_exp_f32 v74, v74
  v_exp_f32 v75, v75
  v_mfma_f32_32x32x8_bf16 v[52:67], v[30:31], v[16:17], v[52:67]
  s_mov_b64 exec, s[22:23]
  ds_read_b128 v[44:47], v5 offset:2560
  ds_read_b128 v[48:51], v5 offset:3200
  s_mov_b64 exec, -1
  v_exp_f32 v76, v76
  v_exp_f32 v77, v77
  v_exp_f32 v78, v78
  v_exp_f32 v79, v79
  v_smfmac_f32_32x32x32_bf16 v[100:115], v[36:39], v[68:75], v6
  v_exp_f32 v80, v80
  v_exp_f32 v81, v81
  v_exp_f32 v82, v82
  v_exp_f32 v83, v83
  v_exp_f32 v52, v52
  v_exp_f32 v53, v53
  v_smfmac_f32_32x32x32_bf16 v[100:115], v[40:43], v[76:83], v6
  v_exp_f32 v54, v54
  v_exp_f32 v55, v55
  v_mfma_f32_32x32x16_bf16 v[68:83], v[32:35], v[20:23], 0
  v_exp_f32 v56, v56
  v_exp_f32 v57, v57
  v_exp_f32 v58, v58
  v_exp_f32 v59, v59
  v_mfma_f32_32x32x8_bf16 v[68:83], v[30:31], v[18:19], v[68:83]
  s_waitcnt lgkmcnt(0)
  s_cbranch_vccnz P2_SY1
P2_SY1_RET:
  ds_read_b128 v[32:35], v3 offset:7680
  ds_read_b32 v30, v4 offset:7680
  v_exp_f32 v60, v60
  v_exp_f32 v61, v61
  v_exp_f32 v62, v62
  v_exp_f32 v63, v63
  v_smfmac_f32_32x32x32_bf16 v[84:99], v[44:47], v[52:59], v6
  v_exp_f32 v64, v64
  v_exp_f32 v65, v65
  v_exp_f32 v66, v66
  v_exp_f32 v67, v67
  v_exp_f32 v68, v68
  v_exp_f32 v69, v69
  v_smfmac_f32_32x32x32_bf16 v[84:99], v[48:51], v[60:67], v6
  v_exp_f32 v70, v70
  v_exp_f32 v71, v71
  v_mfma_f32_32x32x16_bf16 v[52:67], v[24:27], v[12:15], 0
  v_exp_f32 v72, v72
  v_exp_f32 v73, v73
  v_exp_f32 v74, v74
  v_exp_f32 v75, v75
  v_mfma_f32_32x32x8_bf16 v[52:67], v[28:29], v[16:17], v[52:67]
  s_mov_b64 exec, s[22:23]
  ds_read_b128 v[36:39], v5 offset:5120
  ds_read_b128 v[40:43], v5 offset:5760
  s_mov_b64 exec, -1
  v_exp_f32 v76, v76
  v_exp_f32 v77, v77
  v_exp_f32 v78, v78
  v_exp_f32 v79, v79
  v_smfmac_f32_32x32x32_bf16 v[100:115], v[44:47], v[68:75], v6
  v_exp_f32 v80, v80
  v_exp_f32 v81, v81
  v_exp_f32 v82, v82
  v_exp_f32 v83, v83
  v_exp_f32 v52, v52
  v_exp_f32 v53, v53
  v_smfmac_f32_32x32x32_bf16 v[100:115], v[48:51], v[76:83], v6
  v_exp_f32 v54, v54
  v_exp_f32 v55, v55
  v_mfma_f32_32x32x16_bf16 v[68:83], v[24:27], v[20:23], 0
  v_exp_f32 v56, v56
  v_exp_f32 v57, v57
  v_exp_f32 v58, v58
  v_exp_f32 v59, v59
  v_mfma_f32_32x32x8_bf16 v[68:83], v[28:29], v[18:19], v[68:83]
  s_waitcnt lgkmcnt(0)
  ds_read_b128 v[24:27], v3 offset:10240
  ds_read_b32 v28, v4 offset:10240
  v_exp_f32 v60, v60
  v_exp_f32 v61, v61
  v_exp_f32 v62, v62
  v_exp_f32 v63, v63
  v_smfmac_f32_32x32x32_bf16 v[84:99], v[36:39], v[52:59], v6
  v_exp_f32 v64, v64
  v_exp_f32 v65, v65
  v_exp_f32 v66, v66
  v_exp_f32 v67, v67
  v_exp_f32 v68, v68
  v_exp_f32 v69, v69
  v_smfmac_f32_32x32x32_bf16 v[84:99], v[40:43], v[60:67], v6
  v_exp_f32 v70, v70
  v_exp_f32 v71, v71
  v_mfma_f32_32x32x16_bf16 v[52:67], v[32:35], v[12:15], 0
  v_exp_f32 v72, v72
  v_exp_f32 v73, v73
  v_exp_f32 v74, v74
  v_exp_f32 v75, v75
  v_mfma_f32_32x32x8_bf16 v[52:67], v[30:31], v[16:17], v[52:67]
  s_mov_b64 exec, s[22:23]
  ds_read_b128 v[44:47], v5 offset:7680
  ds_read_b128 v[48:51], v5 offset:8320
  s_mov_b64 exec, -1
  v_exp_f32 v76, v76
  v_exp_f32 v77, v77
  v_exp_f32 v78, v78
  v_exp_f32 v79, v79
  v_smfmac_f32_32x32x32_bf16 v[100:115], v[36:39], v[68:75], v6
  v_exp_f32 v80, v80
  v_exp_f32 v81, v81
  v_exp_f32 v82, v82
  v_exp_f32 v83, v83
  v_exp_f32 v52, v52
  v_exp_f32 v53, v53
  v_smfmac_f32_32x32x32_bf16 v[100:115], v[40:43], v[76:83], v6
  v_exp_f32 v54, v54
  v_exp_f32 v55, v55
  v_mfma_f32_32x32x16_bf16 v[68:83], v[32:35], v[20:23], 0
  v_exp_f32 v56, v56
  v_exp_f32 v57, v57
  v_exp_f32 v58, v58
  v_exp_f32 v59, v59
  v_mfma_f32_32x32x8_bf16 v[68:83], v[30:31], v[18:19], v[68:83]
  s_waitcnt lgkmcnt(0)
  ds_read_b128 v[32:35], v3 offset:12800
  ds_read_b32 v30, v4 offset:12800
  v_exp_f32 v60, v60
  v_exp_f32 v61, v61
  v_exp_f32 v62, v62
  v_exp_f32 v63, v63
  v_smfmac_f32_32x32x32_bf16 v[84:99], v[44:47], v[52:59], v6
  v_exp_f32 v64, v64
  v_exp_f32 v65, v65
  v_exp_f32 v66, v66
  v_exp_f32 v67, v67
  v_exp_f32 v68, v68
  v_exp_f32 v69, v69
  v_smfmac_f32_32x32x32_bf16 v[84:99], v[48:51], v[60:67], v6
  v_exp_f32 v70, v70
  v_exp_f32 v71, v71
  v_mfma_f32_32x32x16_bf16 v[52:67], v[24:27], v[12:15], 0
  v_exp_f32 v72, v72
  v_exp_f32 v73, v73
  v_exp_f32 v74, v74
  v_exp_f32 v75, v75
  v_mfma_f32_32x32x8_bf16 v[52:67], v[28:29], v[16:17], v[52:67]
  s_mov_b64 exec, s[22:23]
  ds_read_b128 v[36:39], v5 offset:10240
  ds_read_b128 v[40:43], v5 offset:10880
  s_mov_b64 exec, -1
  v_exp_f32 v76, v76
  v_exp_f32 v77, v77
  v_exp_f32 v78, v78
  v_exp_f32 v79, v79
  v_smfmac_f32_32x32x32_bf16 v[100:115], v[44:47], v[68:75], v6
  v_exp_f32 v80, v80
  v_exp_f32 v81, v81
  v_exp_f32 v82, v82
  v_exp_f32 v83, v83
  v_exp_f32 v52, v52
  v_exp_f32 v53, v53
  v_smfmac_f32_32x32x32_bf16 v[100:115], v[48:51], v[76:83], v6
  v_exp_f32 v54, v54
  v_exp_f32 v55, v55
  v_mfma_f32_32x32x16_bf16 v[68:83], v[24:27], v[20:23], 0
  v_exp_f32 v56, v56
  v_exp_f32 v57, v57
  v_exp_f32 v58, v58
  v_exp_f32 v59, v59
  v_mfma_f32_32x32x8_bf16 v[68:83], v[28:29], v[18:19], v[68:83]
  s_waitcnt lgkmcnt(0)
  s_cbranch_vccnz P2_SY4
P2_SY4_RET:
  ds_read_b128 v[24:27], v3 offset:15360
  ds_read_b32 v28, v4 offset:15360
  v_exp_f32 v60, v60
  v_exp_f32 v61, v61
  v_exp_f32 v62, v62
  v_exp_f32 v63, v63
  v_smfmac_f32_32x32x32_bf16 v[84:99], v[36:39], v[52:59], v6
  v_exp_f32 v64, v64
  v_exp_f32 v65, v65
  v_exp_f32 v66, v66
  v_exp_f32 v67, v67
  v_exp_f32 v68, v68
  v_exp_f32 v69, v69
  v_smfmac_f32_32x32x32_bf16 v[84:99], v[40:43], v[60:67], v6
  v_exp_f32 v70, v70
  v_exp_f32 v71, v71
  v_mfma_f32_32x32x16_bf16 v[52:67], v[32:35], v[12:15], 0
  v_exp_f32 v72, v72
  v_exp_f32 v73, v73
  v_exp_f32 v74, v74
  v_exp_f32 v75, v75
  v_mfma_f32_32x32x8_bf16 v[52:67], v[30:31], v[16:17], v[52:67]
  s_mov_b64 exec, s[22:23]
  ds_read_b128 v[44:47], v5 offset:12800
  ds_read_b128 v[48:51], v5 offset:13440
  s_mov_b64 exec, -1
  v_exp_f32 v76, v76
  v_exp_f32 v77, v77
  v_exp_f32 v78, v78
  v_exp_f32 v79, v79
  v_smfmac_f32_32x32x32_bf16 v[100:115], v[36:39], v[68:75], v6
  v_exp_f32 v80, v80
  v_exp_f32 v81, v81
  v_exp_f32 v82, v82
  v_exp_f32 v83, v83
  v_exp_f32 v52, v52
  v_exp_f32 v53, v53
  v_smfmac_f32_32x32x32_bf16 v[100:115], v[40:43], v[76:83], v6
  v_exp_f32 v54, v54
  v_exp_f32 v55, v55
  v_mfma_f32_32x32x16_bf16 v[68:83], v[32:35], v[20:23], 0
  v_exp_f32 v56, v56
  v_exp_f32 v57, v57
  v_exp_f32 v58, v58
  v_exp_f32 v59, v59
  v_mfma_f32_32x32x8_bf16 v[68:83], v[30:31], v[18:19], v[68:83]
  s_waitcnt lgkmcnt(0)
  ds_read_b128 v[32:35], v3 offset:17920
  ds_read_b32 v30, v4 offset:17920
  v_exp_f32 v60, v60
  v_exp_f32 v61, v61
  v_exp_f32 v62, v62
  v_exp_f32 v63, v63
  v_smfmac_f32_32x32x32_bf16 v[84:99], v[44:47], v[52:59], v6
  v_exp_f32 v64, v64
  v_exp_f32 v65, v65
  v_exp_f32 v66, v66
  v_exp_f32 v67, v67
  v_exp_f32 v68, v68
  v_exp_f32 v69, v69
  v_smfmac_f32_32x32x32_bf16 v[84:99], v[48:51], v[60:67], v6
  v_exp_f32 v70, v70
  v_exp_f32 v71, v71
  v_mfma_f32_32x32x16_bf16 v[52:67], v[24:27], v[12:15], 0
  v_exp_f32 v72, v72
  v_exp_f32 v73, v73
  v_exp_f32 v74, v74
  v_exp_f32 v75, v75
  v_mfma_f32_32x32x8_bf16 v[52:67], v[28:29], v[16:17], v[52:67]
  s_mov_b64 exec, s[22:23]
  ds_read_b128 v[36:39], v5 offset:15360
  ds_read_b128 v[40:43], v5 offset:16000
  s_mov_b64 exec, -1
  v_exp_f32 v76, v76
  v_exp_f32 v77, v77
  v_exp_f32 v78, v78
  v_exp_f32 v79, v79
  v_smfmac_f32_32x32x32_bf16 v[100:115], v[44:47], v[68:75], v6
  v_exp_f32 v80, v80
  v_exp_f32 v81, v81
  v_exp_f32 v82, v82
  v_exp_f32 v83, v83
  v_exp_f32 v52, v52
  v_exp_f32 v53, v53
  v_smfmac_f32_32x32x32_bf16 v[100:115], v[48:51], v[76:83], v6
  v_exp_f32 v54, v54
  v_exp_f32 v55, v55
  v_mfma_f32_32x32x16_bf16 v[68:83], v[24:27], v[20:23], 0
  v_exp_f32 v56, v56
  v_exp_f32 v57, v57
  v_exp_f32 v58, v58
  v_exp_f32 v59, v59
  v_mfma_f32_32x32x8_bf16 v[68:83], v[28:29], v[18:19], v[68:83]
  s_waitcnt lgkmcnt(0)
  ds_read_b128 v[24:27], v3 offset:20480
  ds_read_b32 v28, v4 offset:20480
  s_bitcmp1_b32 s24, s20
  s_cbranch_scc1 P2_LOWP
P2_LOWP_RET:
  v_exp_f32 v60, v60
  v_exp_f32 v61, v61
  v_exp_f32 v62, v62
  v_exp_f32 v63, v63
  v_smfmac_f32_32x32x32_bf16 v[84:99], v[36:39], v[52:59], v6
  v_exp_f32 v64, v64
  v_exp_f32 v65, v65
  v_exp_f32 v66, v66
  v_exp_f32 v67, v67
  v_exp_f32 v68, v68
  v_exp_f32 v69, v69
  v_smfmac_f32_32x32x32_bf16 v[84:99], v[40:43], v[60:67], v6
  v_exp_f32 v70, v70
  v_exp_f32 v71, v71
  v_mfma_f32_32x32x16_bf16 v[52:67], v[32:35], v[12:15], 0
  v_exp_f32 v72, v72
  v_exp_f32 v73, v73
  v_exp_f32 v74, v74
  v_exp_f32 v75, v75
  v_mfma_f32_32x32x8_bf16 v[52:67], v[30:31], v[16:17], v[52:67]
  s_mov_b64 exec, s[22:23]
  ds_read_b128 v[44:47], v5 offset:17920
  ds_read_b128 v[48:51], v5 offset:18560
  s_mov_b64 exec, -1
  v_exp_f32 v76, v76
  v_exp_f32 v77, v77
  v_exp_f32 v78, v78
  v_exp_f32 v79, v79
  v_smfmac_f32_32x32x32_bf16 v[100:115], v[36:39], v[68:75], v6
  v_exp_f32 v80, v80
  v_exp_f32 v81, v81
  v_exp_f32 v82, v82
  v_exp_f32 v83, v83
  v_exp_f32 v52, v52
  v_exp_f32 v53, v53
  v_smfmac_f32_32x32x32_bf16 v[100:115], v[40:43], v[76:83], v6
  v_exp_f32 v54, v54
  v_exp_f32 v55, v55
  v_mfma_f32_32x32x16_bf16 v[68:83], v[32:35], v[20:23], 0
  v_exp_f32 v56, v56
  v_exp_f32 v57, v57
  v_exp_f32 v58, v58
  v_exp_f32 v59, v59
  v_mfma_f32_32x32x8_bf16 v[68:83], v[30:31], v[18:19], v[68:83]
  s_waitcnt lgkmcnt(0)
  ds_read_b128 v[32:35], v3 offset:23040
  ds_read_b32 v30, v4 offset:23040
  v_exp_f32 v60, v60
  v_exp_f32 v61, v61
  v_exp_f32 v62, v62
  v_exp_f32 v63, v63
  v_smfmac_f32_32x32x32_bf16 v[84:99], v[44:47], v[52:59], v6
  v_exp_f32 v64, v64
  v_exp_f32 v65, v65
  v_exp_f32 v66, v66
  v_exp_f32 v67, v67
  v_exp_f32 v68, v68
  v_exp_f32 v69, v69
  v_smfmac_f32_32x32x32_bf16 v[84:99], v[48:51], v[60:67], v6
  v_exp_f32 v70, v70
  v_exp_f32 v71, v71
  v_mfma_f32_32x32x16_bf16 v[52:67], v[24:27], v[12:15], 0
  v_exp_f32 v72, v72
  v_exp_f32 v73, v73
  v_exp_f32 v74, v74
  v_exp_f32 v75, v75
  v_mfma_f32_32x32x8_bf16 v[52:67], v[28:29], v[16:17], v[52:67]
  s_mov_b64 exec, s[22:23]
  ds_read_b128 v[36:39], v5 offset:20480
  ds_read_b128 v[40:43], v5 offset:21120
  s_mov_b64 exec, -1
  v_exp_f32 v76, v76
  v_exp_f32 v77, v77
  v_exp_f32 v78, v78
  v_exp_f32 v79, v79
  v_smfmac_f32_32x32x32_bf16 v[100:115], v[44:47], v[68:75], v6
  v_exp_f32 v80, v80
  v_exp_f32 v81, v81
  v_exp_f32 v82, v82
  v_exp_f32 v83, v83
  v_add_u32 v3, 20480, v3
  v_add_u32 v4, 20480, v4
  v_add_u32 v5, 20480, v5
  s_add_u32 s20, s20, 1
  s_mov_b64 vcc, 0
  s_bitcmp1_b32 0x24, s20
  s_cbranch_scc0 P2_NOBAR
  s_barrier
  s_setprio 3
  s_branch P2_LOOP
P2_LOWP:
  s_setprio 0
  s_branch P2_LOWP_RET
P2_SY1:
  s_waitcnt vmcnt(2)
  s_barrier
  s_branch P2_SY1_RET
P2_SY4:
  s_waitcnt vmcnt(0)
  s_barrier
  s_branch P2_SY4_RET
P2_LOADER:
  s_load_dwordx2 s[52:53], s[0:1], 16
  s_load_dwordx2 s[54:55], s[0:1], 56
  s_mov_b32 s60, 0xCCCCCCCD
  v_mul_hi_u32 v9, v1, s60
  v_lshrrev_b32 v9, 3, v9
  v_mul_u32_u24 v10, 10, v9
  v_sub_u32 v10, v1, v10
  v_mul_u32_u24 v9, 1280, v9
  v_lshl_add_u32 v8, v10, 4, v9
  s_lshr_b32 s56, s14, 2
  s_mul_i32 s56, s56, 160
  s_mov_b32 s34, 819200
  s_mov_b32 s35, 0x00020000
  s_cmp_lt_u32 s13, 4
  s_waitcnt lgkmcnt(0)
  s_cselect_b32 s32, s52, s54
  s_cselect_b32 s33, s53, s55
  s_add_u32 s27, s27, 24576
  s_mov_b32 m0, 32768
  s_mov_b32 s20, 1
  s_barrier
  s_barrier
  s_barrier
P2_LD1:
  buffer_load_dwordx4 v2, s[8:11], s27 offen lds
  s_add_u32 m0, m0, 1024
  s_add_u32 s27, s27, 1024
  buffer_load_dwordx4 v2, s[8:11], s27 offen lds
  s_add_u32 m0, m0, 1024
  s_add_u32 s27, s27, 1024
  buffer_load_dwordx4 v2, s[8:11], s27 offen lds
  s_add_u32 m0, m0, 1024
  s_add_u32 s27, s27, 1024
  buffer_load_dwordx4 v2, s[8:11], s27 offen lds
  s_add_u32 m0, m0, 1024
  s_add_u32 s27, s27, 1024
  buffer_load_dwordx4 v2, s[8:11], s27 offen lds
  s_add_u32 m0, m0, 1024
  s_add_u32 s27, s27, 1024
  buffer_load_dwordx4 v2, s[8:11], s27 offen lds
  s_add_u32 m0, m0, 1024
  s_add_u32 s27, s27, 1024
  buffer_load_dwordx4 v2, s[8:11], s27 offen lds
  s_add_u32 m0, m0, 1024
  s_add_u32 s27, s27, 1024
  buffer_load_dwordx4 v2, s[8:11], s27 offen lds
  s_add_u32 m0, m0, 1024
  s_add_u32 s27, s27, 1024
  s_add_u32 s20, s20, 1
  s_cmp_eq_u32 s20, 2
  s_cbranch_scc0 P2_LD2
  s_barrier
P2_LD2:
  s_cmp_eq_u32 s20, 5
  s_cbranch_scc0 P2_LD3
  s_waitcnt vmcnt(16)
  s_barrier
P2_LD3:
  s_cmp_lt_u32 s20, 17
  s_cbranch_scc1 P2_LD1
  s_waitcnt vmcnt(0)
  s_barrier
  s_mul_i32 s36, s15, 2621440
  s_lshl_b32 s37, s18, 5
  s_lshl_b32 s38, 0, 2
  s_add_u32 s37, s37, s38
  s_mul_i32 s37, s37, 20480
  s_add_u32 s36, s36, s37
  s_add_u32 s36, s36, 10747904
  s_lshr_b32 s37, s17, 1
  s_lshl_b32 s37, s37, 10
  s_and_b32 s38, s17, 1
  s_lshl_b32 s38, s38, 9
  s_add_u32 s37, s37, s38
  s_add_u32 s37, s37, s36
  s_lshr_b32 s38, s17, 3
  s_lshl_b32 s38, s38, 10
  s_add_u32 s38, s38, 16384
  s_bfe_u32 s39, s17, 0x10002
  s_lshl_b32 s39, s39, 9
  s_add_u32 s38, s38, s39
  s_and_b32 s39, s17, 1
  s_lshl_b32 s39, s39, 8
  s_add_u32 s38, s38, s39
  s_bfe_u32 s39, s17, 0x10001
  s_lshl_b32 s39, s39, 3
  s_add_u32 s38, s38, s39
  s_add_u32 s38, s38, s36
  v_and_b32 v12, 31, v1
  v_lshlrev_b32 v12, 4, v12
  v_lshrrev_b32 v13, 5, v1
  v_mul_u32_u24 v13, 20480, v13
  v_add_u32 v12, v12, v13
  v_and_b32 v13, 15, v1
  v_lshlrev_b32 v13, 4, v13
  v_lshrrev_b32 v14, 4, v1
  v_mul_u32_u24 v14, 20480, v14
  v_add_u32 v13, v13, v14
  v_mov_b32 v16, -1
  v_mov_b32 v17, -1
  v_mov_b32 v18, -1
  v_mov_b32 v19, -1
  s_mov_b32 s59, 0
P2_PO:
  buffer_store_dwordx4 v[16:19], v12, s[8:11], s37 offen sc1
  s_add_u32 s37, s37, 40960
  buffer_store_dwordx4 v[16:19], v12, s[8:11], s37 offen sc1
  s_add_u32 s37, s37, 40960
  buffer_store_dwordx2 v[16:17], v13, s[8:11], s38 offen sc1
  s_add_u32 s38, s38, 81920
  s_add_u32 s59, s59, 1
  s_cmp_lt_u32 s59, 8
  s_cbranch_scc1 P2_PO
  s_memrealtime s[44:45]
  s_lshr_b32 s49, s13, 2
  s_lshl_b32 s49, s49, 4
  s_and_b32 s50, s13, 3
  s_add_u32 s49, s49, s50
  s_lshl_b32 s49, s49, 3
  v_bfe_u32 v10, v1, 3, 2
  v_lshlrev_b32 v10, 5, v10
  v_and_b32 v9, 7, v1
  v_add3_u32 v9, v9, v10, s49
  s_mov_b32 s50, -1
  s_mov_b32 s51, 0
  v_lshlrev_b32 v9, 7, v9
  v_lshlrev_b32 v7, 4, v1
  s_lshl_b32 s48, s2, 7
  s_add_u32 s48, s48, 16023552
  s_mov_b32 s49, 16023552
  s_sub_u32 s46, s6, 0
  s_subb_u32 s47, s7, 0
  s_waitcnt lgkmcnt(0)
  v_mov_b32 v20, s44
  v_mov_b32 v21, s45
  v_mov_b32 v22, s44
  v_mov_b32 v23, s45
  v_mov_b32 v11, s47
  s_waitcnt vmcnt(0)
  s_mov_b64 exec, 0xff
  buffer_store_dwordx4 v[20:23], v7, s[8:11], s48 offen sc1
  s_mov_b64 exec, -1
  s_lshr_b32 s57, s14, 2
  s_cmp_ge_u32 s57, 5
  s_cselect_b32 s58, 5, 0
  s_sub_u32 s57, s57, s58
  s_sub_u32 s57, 5, s57
  s_mul_i32 s57, s57, 0
  s_mov_b32 s59, 0
  s_cmp_ge_u32 s57, 102400
  s_cselect_b32 s57, 0, s57
  s_mov_b32 s58, s56
  s_mov_b64 exec, s[50:51]
  s_mov_b32 s48, 0
HP_POLL:
  buffer_load_dwordx2 v[24:25], v9, s[8:11], s49 offen sc1
  s_add_u32 s48, s48, 1
  s_waitcnt vmcnt(0)
  v_subrev_co_u32 v10, vcc, s46, v24
  s_nop 1
  v_subb_co_u32 v7, vcc, v25, v11, vcc
  v_lshrrev_b32 v10, 24, v10
  v_or_b32 v10, v10, v7
  v_cmp_eq_u32 vcc, 0, v10
  s_cmp_ge_u32 s48, 65536
  s_cbranch_scc1 HP_OUT
  s_nop 1
  s_cmp_eq_u64 vcc, s[50:51]
  s_cbranch_scc1 HP_OUT
  s_sleep 4
  s_branch HP_POLL
HP_OUT:
  s_mov_b64 exec, -1
  s_barrier
P2_LW1:
  s_add_u32 m0, s57, 0
  s_add_u32 s62, s58, 0
  s_mov_b32 exec_hi, 0x0fffffff
  buffer_load_dwordx4 v8, s[32:35], s62 offen lds
  s_add_u32 m0, s57, 960
  s_add_u32 s62, s58, 7680
  s_mov_b32 exec_hi, 0x0fffffff
  buffer_load_dwordx4 v8, s[32:35], s62 offen lds
  s_add_u32 m0, s57, 1920
  s_add_u32 s62, s58, 15360
  s_mov_b32 exec_hi, 0xff
  buffer_load_dwordx4 v8, s[32:35], s62 offen lds
  s_add_u32 m0, s57, 2560
  s_add_u32 s62, s58, 25600
  s_mov_b32 exec_hi, 0x0fffffff
  buffer_load_dwordx4 v8, s[32:35], s62 offen lds
  s_add_u32 m0, s57, 3520
  s_add_u32 s62, s58, 33280
  s_mov_b32 exec_hi, 0x0fffffff
  buffer_load_dwordx4 v8, s[32:35], s62 offen lds
  s_add_u32 m0, s57, 4480
  s_add_u32 s62, s58, 40960
  s_mov_b32 exec_hi, 0xff
  buffer_load_dwordx4 v8, s[32:35], s62 offen lds
  s_add_u32 s57, s57, 5120
  s_cmp_ge_u32 s57, 102400
  s_cselect_b32 s57, 0, s57
  s_add_u32 s58, s58, 51200
  s_add_u32 s59, s59, 1
  s_cmp_lt_u32 s59, 16
  s_cbranch_scc1 P2_LW1
  s_add_u32 s58, s56, 20480
P2_LW2:
  s_mov_b32 m0, s57
  s_add_u32 s57, s57, 640
  buffer_load_dwordx4 v8, s[32:35], s58 offen lds
  s_add_u32 s58, s58, 25600
  s_add_u32 s59, s59, 1
  s_cmp_lt_u32 s59, 48
  s_cbranch_scc1 P2_LW2
  s_waitcnt vmcnt(0)
  s_barrier
  s_endpgm
P2_NOBAR:
  s_setprio 2
  s_bitcmp1_b32 0x48, s20
  s_cbranch_scc1 P2_LOOP
  s_setprio 1
  s_cmp_lt_u32 s20, 8
  s_cbranch_scc1 P2_LOOP
  s_setprio 0
  v_smfmac_f32_32x32x32_bf16 v[100:115], v[48:51], v[76:83], v6
  s_waitcnt lgkmcnt(0)
  s_nop 15
  v_mov_b32 v7, v96
  v_mov_b32 v8, v112
  s_nop 1
  v_permlane32_swap_b32 v96, v7
  v_permlane32_swap_b32 v112, v8
  s_nop 1
  s_mov_b32 s30, 0x30800000
  s_mov_b32 s31, 0x76800000
  v_mul_f32 v7, 0, v84
  v_fma_f32 v7, v85, 0, v7
  v_fma_f32 v7, v86, 0, v7
  v_fma_f32 v7, v87, 0, v7
  v_fma_f32 v7, v88, 0, v7
  v_fma_f32 v7, v89, 0, v7
  v_fma_f32 v7, v90, 0, v7
  v_fma_f32 v7, v91, 0, v7
  v_fma_f32 v7, v92, 0, v7
  v_fma_f32 v7, v93, 0, v7
  v_fma_f32 v7, v94, 0, v7
  v_fma_f32 v7, v95, 0, v7
  v_fma_f32 v7, v100, 0, v7
  v_fma_f32 v7, v101, 0, v7
  v_fma_f32 v7, v102, 0, v7
  v_fma_f32 v7, v103, 0, v7
  v_fma_f32 v7, v104, 0, v7
  v_fma_f32 v7, v105, 0, v7
  v_fma_f32 v7, v106, 0, v7
  v_fma_f32 v7, v107, 0, v7
  v_fma_f32 v7, v108, 0, v7
  v_fma_f32 v7, v109, 0, v7
  v_fma_f32 v7, v110, 0, v7
  v_fma_f32 v7, v111, 0, v7
  v_min_f32 v8, v96, v112
  v_max_f32 v9, v96, v112
  v_add_f32 v7, v7, v96
  v_add_f32 v7, v7, v112
  v_cmp_le_f32 vcc, s30, v8
  v_cmp_ge_f32 s[32:33], s31, v9
  v_cmp_o_f32 s[34:35], v7, v7
  s_nop 3
  s_and_b64 vcc, vcc, s[32:33]
  s_and_b64 vcc, vcc, s[34:35]
  s_cmp_eq_u64 vcc, -1
  s_cbranch_scc0 P2_FALLBACK
P2_STORE:
  s_mul_i32 s36, s15, 2621440
  s_lshl_b32 s37, s18, 5
  s_lshl_b32 s38, s3, 2
  s_add_u32 s37, s37, s38
  s_mul_i32 s37, s37, 20480
  s_add_u32 s36, s36, s37
  s_add_u32 s36, s36, 10747904
  s_lshr_b32 s37, s17, 1
  s_lshl_b32 s37, s37, 10
  s_and_b32 s38, s17, 1
  s_lshl_b32 s38, s38, 9
  s_add_u32 s37, s37, s38
  s_add_u32 s37, s37, s36
  s_lshr_b32 s38, s17, 3
  s_lshl_b32 s38, s38, 10
  s_add_u32 s38, s38, 16384
  s_bfe_u32 s39, s17, 0x10002
  s_lshl_b32 s39, s39, 9
  s_add_u32 s38, s38, s39
  s_and_b32 s39, s17, 1
  s_lshl_b32 s39, s39, 8
  s_add_u32 s38, s38, s39
  s_bfe_u32 s39, s17, 0x10001
  s_lshl_b32 s39, s39, 3
  s_add_u32 s38, s38, s39
  s_add_u32 s38, s38, s36
  v_and_b32 v7, 15, v1
  v_lshlrev_b32 v7, 4, v7
  v_bfe_u32 v8, v1, 4, 1
  v_mul_u32_u24 v8, 20480, v8
  v_add_u32 v7, v7, v8
  v_lshrrev_b32 v8, 5, v1
  v_lshl_add_u32 v8, v8, 8, v7
  v_rcp_f32 v10, v96
  v_rcp_f32 v11, v112
  s_add_u32 s40, s37, 40960
  s_add_u32 s41, s38, 40960
  v_mul_f32 v84, v84, v10
  v_mul_f32 v85, v85, v10
  v_mul_f32 v86, v86, v10
  v_mul_f32 v87, v87, v10
  v_mul_f32 v88, v88, v10
  v_mul_f32 v89, v89, v10
  v_mul_f32 v90, v90, v10
  v_mul_f32 v91, v91, v10
  v_mul_f32 v92, v92, v10
  v_mul_f32 v93, v93, v10
  v_mul_f32 v94, v94, v10
  v_mul_f32 v95, v95, v10
  v_cvt_pk_bf16_f32 v52, v84, v85
  v_cvt_pk_bf16_f32 v53, v86, v87
  v_cvt_pk_bf16_f32 v54, v88, v89
  v_cvt_pk_bf16_f32 v55, v90, v91
  v_cvt_pk_bf16_f32 v56, v92, v93
  v_cvt_pk_bf16_f32 v57, v94, v95
  v_mul_f32 v100, v100, v11
  v_mul_f32 v101, v101, v11
  v_mul_f32 v102, v102, v11
  v_mul_f32 v103, v103, v11
  v_mul_f32 v104, v104, v11
  v_mul_f32 v105, v105, v11
  v_mul_f32 v106, v106, v11
  v_mul_f32 v107, v107, v11
  v_mul_f32 v108, v108, v11
  v_mul_f32 v109, v109, v11
  v_mul_f32 v110, v110, v11
  v_mul_f32 v111, v111, v11
  v_cvt_pk_bf16_f32 v68, v100, v101
  v_cvt_pk_bf16_f32 v69, v102, v103
  v_cvt_pk_bf16_f32 v70, v104, v105
  v_cvt_pk_bf16_f32 v71, v106, v107
  v_cvt_pk_bf16_f32 v72, v108, v109
  v_cvt_pk_bf16_f32 v73, v110, v111
  buffer_store_dwordx4 v[52:55], v8, s[8:11], s37 offen sc1
  buffer_store_dwordx4 v[68:71], v8, s[8:11], s40 offen sc1
  s_mov_b32 exec_hi, 0
  buffer_store_dwordx2 v[56:57], v7, s[8:11], s38 offen sc1
  buffer_store_dwordx2 v[72:73], v7, s[8:11], s41 offen sc1
  s_mov_b64 exec, -1
  s_branch P2_DONE
P2_FALLBACK:
  v_mov_b32 v116, 0xff800000
  v_mov_b32 v117, 0xff800000
  v_subrev_u32 v4, 163840, v4
  v_subrev_u32 v5, 163840, v5
  s_mul_i32 s27, s21, 163840
  s_add_u32 s27, s27, 5242880
  s_mov_b32 s26, s27
  s_mov_b32 s20, 0
P2_FB1:
  buffer_load_dwordx4 v[24:27], v2, s[8:11], s26 offen
  buffer_load_dword v28, v4, s[8:11], s26 offen
  s_add_u32 s26, s26, 2560
  s_waitcnt vmcnt(0)
  v_mfma_f32_32x32x16_bf16 v[52:67], v[24:27], v[12:15], 0
  v_mfma_f32_32x32x8_bf16 v[52:67], v[28:29], v[16:17], v[52:67]
  v_mfma_f32_32x32x16_bf16 v[68:83], v[24:27], v[20:23], 0
  v_mfma_f32_32x32x8_bf16 v[68:83], v[28:29], v[18:19], v[68:83]
  s_nop 15
  v_max3_f32 v116, v52, v53, v116
  v_max3_f32 v117, v68, v69, v117
  v_max3_f32 v116, v54, v55, v116
  v_max3_f32 v117, v70, v71, v117
  v_max3_f32 v116, v56, v57, v116
  v_max3_f32 v117, v72, v73, v117
  v_max3_f32 v116, v58, v59, v116
  v_max3_f32 v117, v74, v75, v117
  v_max3_f32 v116, v60, v61, v116
  v_max3_f32 v117, v76, v77, v117
  v_max3_f32 v116, v62, v63, v116
  v_max3_f32 v117, v78, v79, v117
  v_max3_f32 v116, v64, v65, v116
  v_max3_f32 v117, v80, v81, v117
  v_max3_f32 v116, v66, v67, v116
  v_max3_f32 v117, v82, v83, v117
  s_add_u32 s20, s20, 1
  s_cmp_lt_u32 s20, 64
  s_cbranch_scc1 P2_FB1
  v_mov_b32 v7, v116
  v_mov_b32 v8, v117
  s_nop 1
  v_permlane32_swap_b32 v7, v116
  v_permlane32_swap_b32 v8, v117
  s_nop 1
  v_max_f32 v116, v116, v7
  v_max_f32 v117, v117, v8
  v_mov_b32 v84, 0
  v_mov_b32 v85, 0
  v_mov_b32 v86, 0
  v_mov_b32 v87, 0
  v_mov_b32 v88, 0
  v_mov_b32 v89, 0
  v_mov_b32 v90, 0
  v_mov_b32 v91, 0
  v_mov_b32 v92, 0
  v_mov_b32 v93, 0
  v_mov_b32 v94, 0
  v_mov_b32 v95, 0
  v_mov_b32 v96, 0
  v_mov_b32 v97, 0
  v_mov_b32 v98, 0
  v_mov_b32 v99, 0
  v_mov_b32 v100, 0
  v_mov_b32 v101, 0
  v_mov_b32 v102, 0
  v_mov_b32 v103, 0
  v_mov_b32 v104, 0
  v_mov_b32 v105, 0
  v_mov_b32 v106, 0
  v_mov_b32 v107, 0
  v_mov_b32 v108, 0
  v_mov_b32 v109, 0
  v_mov_b32 v110, 0
  v_mov_b32 v111, 0
  v_mov_b32 v112, 0
  v_mov_b32 v113, 0
  v_mov_b32 v114, 0
  v_mov_b32 v115, 0
  s_mov_b32 s20, 0
P2_FB2:
  buffer_load_dwordx4 v[24:27], v2, s[8:11], s27 offen
  buffer_load_dword v28, v4, s[8:11], s27 offen
  s_mov_b64 exec, s[22:23]
  buffer_load_dwordx4 v[36:39], v5, s[8:11], s27 offen
  buffer_load_dwordx4 v[40:43], v5, s[8:11], s27 offen offset:640
  s_mov_b64 exec, -1
  s_add_u32 s27, s27, 2560
  s_waitcnt vmcnt(0)
  v_mfma_f32_32x32x16_bf16 v[52:67], v[24:27], v[12:15], 0
  v_mfma_f32_32x32x8_bf16 v[52:67], v[28:29], v[16:17], v[52:67]
  v_mfma_f32_32x32x16_bf16 v[68:83], v[24:27], v[20:23], 0
  v_mfma_f32_32x32x8_bf16 v[68:83], v[28:29], v[18:19], v[68:83]
  s_nop 15
  v_sub_f32 v52, v52, v116
  v_sub_f32 v68, v68, v117
  v_sub_f32 v53, v53, v116
  v_sub_f32 v69, v69, v117
  v_sub_f32 v54, v54, v116
  v_sub_f32 v70, v70, v117
  v_sub_f32 v55, v55, v116
  v_sub_f32 v71, v71, v117
  v_sub_f32 v56, v56, v116
  v_sub_f32 v72, v72, v117
  v_sub_f32 v57, v57, v116
  v_sub_f32 v73, v73, v117
  v_sub_f32 v58, v58, v116
  v_sub_f32 v74, v74, v117
  v_sub_f32 v59, v59, v116
  v_sub_f32 v75, v75, v117
  v_sub_f32 v60, v60, v116
  v_sub_f32 v76, v76, v117
  v_sub_f32 v61, v61, v116
  v_sub_f32 v77, v77, v117
  v_sub_f32 v62, v62, v116
  v_sub_f32 v78, v78, v117
  v_sub_f32 v63, v63, v116
  v_sub_f32 v79, v79, v117
  v_sub_f32 v64, v64, v116
  v_sub_f32 v80, v80, v117
  v_sub_f32 v65, v65, v116
  v_sub_f32 v81, v81, v117
  v_sub_f32 v66, v66, v116
  v_sub_f32 v82, v82, v117
  v_sub_f32 v67, v67, v116
  v_sub_f32 v83, v83, v117
  v_exp_f32 v52, v52
  v_exp_f32 v53, v53
  v_exp_f32 v54, v54
  v_exp_f32 v55, v55
  v_exp_f32 v56, v56
  v_exp_f32 v57, v57
  v_exp_f32 v58, v58
  v_exp_f32 v59, v59
  v_exp_f32 v60, v60
  v_exp_f32 v61, v61
  v_exp_f32 v62, v62
  v_exp_f32 v63, v63
  v_exp_f32 v64, v64
  v_exp_f32 v65, v65
  v_exp_f32 v66, v66
  v_exp_f32 v67, v67
  v_exp_f32 v68, v68
  v_exp_f32 v69, v69
  v_exp_f32 v70, v70
  v_exp_f32 v71, v71
  v_exp_f32 v72, v72
  v_exp_f32 v73, v73
  v_exp_f32 v74, v74
  v_exp_f32 v75, v75
  v_exp_f32 v76, v76
  v_exp_f32 v77, v77
  v_exp_f32 v78, v78
  v_exp_f32 v79, v79
  v_exp_f32 v80, v80
  v_exp_f32 v81, v81
  v_exp_f32 v82, v82
  v_exp_f32 v83, v83
  s_nop 1
  v_smfmac_f32_32x32x32_bf16 v[84:99], v[36:39], v[52:59], v6
  v_smfmac_f32_32x32x32_bf16 v[84:99], v[40:43], v[60:67], v6
  v_smfmac_f32_32x32x32_bf16 v[100:115], v[36:39], v[68:75], v6
  v_smfmac_f32_32x32x32_bf16 v[100:115], v[40:43], v[76:83], v6
  s_add_u32 s20, s20, 1
  s_cmp_lt_u32 s20, 64
  s_cbranch_scc1 P2_FB2
  s_nop 15
  v_mov_b32 v7, v96
  v_mov_b32 v8, v112
  s_nop 1
  v_permlane32_swap_b32 v96, v7
  v_permlane32_swap_b32 v112, v8
  s_nop 1
  s_branch P2_STORE
P2_DONE:
  s_barrier
  s_cmp_lt_u32 s3, 4
  s_cbranch_scc1 P3_GO
  s_endpgm
P3_GO:
  buffer_load_dwordx4 v[96:99], v2, s[8:11], s60 offen offset:0 sc1
  buffer_load_dwordx4 v[100:103], v2, s[8:11], s61 offen offset:0 sc1
  buffer_load_dwordx4 v[104:107], v2, s[8:11], s60 offen offset:1024 sc1
  buffer_load_dwordx4 v[108:111], v2, s[8:11], s61 offen offset:1024 sc1
  buffer_load_dwordx4 v[112:115], v2, s[8:11], s60 offen offset:2048 sc1
  buffer_load_dwordx4 v[116:119], v2, s[8:11], s61 offen offset:2048 sc1
  buffer_load_dwordx4 v[120:123], v2, s[8:11], s60 offen offset:3072 sc1
  buffer_load_dwordx4 v[124:127], v2, s[8:11], s61 offen offset:3072 sc1
  buffer_load_dwordx4 v[128:131], v2, s[8:11], s62 offen offset:0 sc1
  buffer_load_dwordx4 v[132:135], v2, s[8:11], s63 offen offset:0 sc1
  buffer_load_dwordx4 v[136:139], v2, s[8:11], s62 offen offset:1024 sc1
  buffer_load_dwordx4 v[140:143], v2, s[8:11], s63 offen offset:1024 sc1
  buffer_load_dwordx4 v[144:147], v2, s[8:11], s62 offen offset:2048 sc1
  buffer_load_dwordx4 v[148:151], v2, s[8:11], s63 offen offset:2048 sc1
  s_load_dwordx2 s[36:37], s[0:1], 64
  s_mov_b32 s28, 0xCCCCCCCD
  s_mov_b32 s38, 5242880
  s_mov_b32 s39, 0x00020000
  s_mov_b32 s70, 0
  v_lshrrev_b32 v4, 5, v1
  v_lshlrev_b32 v4, 4, v4
  v_bfe_u32 v5, v1, 4, 1
  v_lshl_add_u32 v4, v5, 2, v4
  v_bfe_u32 v5, v1, 2, 2
  v_add_u32 v4, v4, v5
  v_mul_u32_u24 v4, 160, v4
  v_and_b32 v5, 3, v1
  v_mul_u32_u24 v5, 40, v5
  v_add_u32 v4, v4, v5
  v_add_u32 v5, 51200, v4
  ds_read_b64_tr_b16 v[16:17], v4 offset:0
  ds_read_b64_tr_b16 v[18:19], v4 offset:1280
  ds_read_b64_tr_b16 v[20:21], v4 offset:8
  ds_read_b64_tr_b16 v[22:23], v4 offset:1288
  ds_read_b64_tr_b16 v[24:25], v4 offset:16
  ds_read_b64_tr_b16 v[26:27], v4 offset:1296
  ds_read_b64_tr_b16 v[28:29], v4 offset:24
  ds_read_b64_tr_b16 v[30:31], v4 offset:1304
  ds_read_b64_tr_b16 v[32:33], v4 offset:32
  ds_read_b64_tr_b16 v[34:35], v4 offset:1312
  v_mov_b32 v56, 0
  v_mov_b32 v57, 0
  v_mov_b32 v58, 0
  v_mov_b32 v59, 0
  v_mov_b32 v60, 0
  v_mov_b32 v61, 0
  v_mov_b32 v62, 0
  v_mov_b32 v63, 0
  v_mov_b32 v64, 0
  v_mov_b32 v65, 0
  v_mov_b32 v66, 0
  v_mov_b32 v67, 0
  v_mov_b32 v68, 0
  v_mov_b32 v69, 0
  v_mov_b32 v70, 0
  v_mov_b32 v71, 0
  v_mov_b32 v72, 0
  v_mov_b32 v73, 0
  v_mov_b32 v74, 0
  v_mov_b32 v75, 0
  v_mov_b32 v76, 0
  v_mov_b32 v77, 0
  v_mov_b32 v78, 0
  v_mov_b32 v79, 0
  v_mov_b32 v80, 0
  v_mov_b32 v81, 0
  v_mov_b32 v82, 0
  v_mov_b32 v83, 0
  v_mov_b32 v84, 0
  v_mov_b32 v85, 0
  v_mov_b32 v86, 0
  v_mov_b32 v87, 0
  v_mov_b32 v88, 0
  v_mov_b32 v89, 0
  v_mov_b32 v90, 0
  v_mov_b32 v91, 0
  v_mov_b32 v92, 0
  v_mov_b32 v93, 0
  v_mov_b32 v94, 0
  v_mov_b32 v95, 0
  v_add_u32 v7, 0, v1
  v_mul_hi_u32 v9, v7, s28
  v_lshrrev_b32 v9, 3, v9
  v_mul_u32_u24 v10, 10, v9
  v_sub_u32 v10, v7, v10
  v_mul_u32_u24 v9, 2560, v9
  v_lshl_add_u32 v6, v10, 4, v9
  v_add_u32 v7, 64, v1
  v_mul_hi_u32 v9, v7, s28
  v_lshrrev_b32 v9, 3, v9
  v_mul_u32_u24 v10, 10, v9
  v_sub_u32 v10, v7, v10
  v_mul_u32_u24 v9, 2560, v9
  v_lshl_add_u32 v8, v10, 4, v9
  v_add_u32 v7, 128, v1
  v_mul_hi_u32 v9, v7, s28
  v_lshrrev_b32 v9, 3, v9
  v_mul_u32_u24 v10, 10, v9
  v_sub_u32 v10, v7, v10
  v_mul_u32_u24 v9, 2560, v9
  v_lshl_add_u32 v12, v10, 4, v9
  v_add_u32 v7, 192, v1
  v_mul_hi_u32 v9, v7, s28
  v_lshrrev_b32 v9, 3, v9
  v_mul_u32_u24 v10, 10, v9
  v_sub_u32 v10, v7, v10
  v_mul_u32_u24 v9, 2560, v9
  v_lshl_add_u32 v13, v10, 4, v9
  v_add_u32 v7, 256, v1
  v_mul_hi_u32 v9, v7, s28
  v_lshrrev_b32 v9, 3, v9
  v_mul_u32_u24 v10, 10, v9
  v_sub_u32 v10, v7, v10
  v_mul_u32_u24 v9, 2560, v9
  v_lshl_add_u32 v14, v10, 4, v9
  v_and_b32 v3, 15, v1
  v_mul_u32_u24 v3, 160, v3
  v_lshrrev_b32 v7, 4, v1
  v_mul_u32_u24 v7, 40, v7
  v_add3_u32 v3, v3, v7, s72
  v_add_u32 v15, s72, v2
  s_waitcnt vmcnt(12)
  v_max3_u32 v7, v96, v97, v98
  v_max3_u32 v9, v99, v100, v101
  v_max3_u32 v7, v102, v103, v7
  v_max_u32 v7, v7, v9
  v_cmp_eq_u32 vcc, -1, v7
  buffer_load_dwordx4 v[152:155], v2, s[8:11], s62 offen offset:3072 sc1
  buffer_load_dwordx4 v[156:159], v2, s[8:11], s63 offen offset:3072 sc1
  s_cbranch_vccnz P3_RT0
P3_OK0:
  s_waitcnt lgkmcnt(0)
  v_mfma_f32_16x16x32_bf16 v[56:59], v[16:19], v[96:99], v[56:59]
  ds_read_b64_tr_b16 v[36:37], v4 offset:5120
  ds_read_b64_tr_b16 v[38:39], v4 offset:6400
  v_mfma_f32_16x16x32_bf16 v[76:79], v[16:19], v[100:103], v[76:79]
  ds_read_b64_tr_b16 v[40:41], v4 offset:5128
  ds_read_b64_tr_b16 v[42:43], v4 offset:6408
  v_mfma_f32_16x16x32_bf16 v[60:63], v[20:23], v[96:99], v[60:63]
  ds_read_b64_tr_b16 v[44:45], v4 offset:5136
  ds_read_b64_tr_b16 v[46:47], v4 offset:6416
  v_mfma_f32_16x16x32_bf16 v[80:83], v[20:23], v[100:103], v[80:83]
  ds_read_b64_tr_b16 v[48:49], v4 offset:5144
  ds_read_b64_tr_b16 v[50:51], v4 offset:6424
  v_mfma_f32_16x16x32_bf16 v[64:67], v[24:27], v[96:99], v[64:67]
  ds_read_b64_tr_b16 v[52:53], v4 offset:5152
  ds_read_b64_tr_b16 v[54:55], v4 offset:6432
  v_mfma_f32_16x16x32_bf16 v[84:87], v[24:27], v[100:103], v[84:87]
  v_mfma_f32_16x16x32_bf16 v[68:71], v[28:31], v[96:99], v[68:71]
  v_mfma_f32_16x16x32_bf16 v[88:91], v[28:31], v[100:103], v[88:91]
  v_mfma_f32_16x16x32_bf16 v[72:75], v[32:35], v[96:99], v[72:75]
  v_mfma_f32_16x16x32_bf16 v[92:95], v[32:35], v[100:103], v[92:95]
  s_waitcnt vmcnt(12)
  v_max3_u32 v7, v104, v105, v106
  v_max3_u32 v9, v107, v108, v109
  v_max3_u32 v7, v110, v111, v7
  v_max_u32 v7, v7, v9
  v_cmp_eq_u32 vcc, -1, v7
  buffer_load_dwordx4 v[96:99], v2, s[8:11], s64 offen offset:0 sc1
  buffer_load_dwordx4 v[100:103], v2, s[8:11], s65 offen offset:0 sc1
  s_cbranch_vccnz P3_RT1
P3_OK1:
  s_waitcnt lgkmcnt(0)
  v_mfma_f32_16x16x32_bf16 v[56:59], v[36:39], v[104:107], v[56:59]
  ds_read_b64_tr_b16 v[16:17], v4 offset:10240
  ds_read_b64_tr_b16 v[18:19], v4 offset:11520
  v_mfma_f32_16x16x32_bf16 v[76:79], v[36:39], v[108:111], v[76:79]
  ds_read_b64_tr_b16 v[20:21], v4 offset:10248
  ds_read_b64_tr_b16 v[22:23], v4 offset:11528
  v_mfma_f32_16x16x32_bf16 v[60:63], v[40:43], v[104:107], v[60:63]
  ds_read_b64_tr_b16 v[24:25], v4 offset:10256
  ds_read_b64_tr_b16 v[26:27], v4 offset:11536
  v_mfma_f32_16x16x32_bf16 v[80:83], v[40:43], v[108:111], v[80:83]
  ds_read_b64_tr_b16 v[28:29], v4 offset:10264
  ds_read_b64_tr_b16 v[30:31], v4 offset:11544
  v_mfma_f32_16x16x32_bf16 v[64:67], v[44:47], v[104:107], v[64:67]
  ds_read_b64_tr_b16 v[32:33], v4 offset:10272
  ds_read_b64_tr_b16 v[34:35], v4 offset:11552
  v_mfma_f32_16x16x32_bf16 v[84:87], v[44:47], v[108:111], v[84:87]
  v_mfma_f32_16x16x32_bf16 v[68:71], v[48:51], v[104:107], v[68:71]
  v_mfma_f32_16x16x32_bf16 v[88:91], v[48:51], v[108:111], v[88:91]
  v_mfma_f32_16x16x32_bf16 v[72:75], v[52:55], v[104:107], v[72:75]
  v_mfma_f32_16x16x32_bf16 v[92:95], v[52:55], v[108:111], v[92:95]
  s_waitcnt vmcnt(12)
  v_max3_u32 v7, v112, v113, v114
  v_max3_u32 v9, v115, v116, v117
  v_max3_u32 v7, v118, v119, v7
  v_max_u32 v7, v7, v9
  v_cmp_eq_u32 vcc, -1, v7
  buffer_load_dwordx4 v[104:107], v2, s[8:11], s64 offen offset:1024 sc1
  buffer_load_dwordx4 v[108:111], v2, s[8:11], s65 offen offset:1024 sc1
  s_cbranch_vccnz P3_RT2
P3_OK2:
  s_waitcnt lgkmcnt(0)
  v_mfma_f32_16x16x32_bf16 v[56:59], v[16:19], v[112:115], v[56:59]
  ds_read_b64_tr_b16 v[36:37], v4 offset:15360
  ds_read_b64_tr_b16 v[38:39], v4 offset:16640
  v_mfma_f32_16x16x32_bf16 v[76:79], v[16:19], v[116:119], v[76:79]
  ds_read_b64_tr_b16 v[40:41], v4 offset:15368
  ds_read_b64_tr_b16 v[42:43], v4 offset:16648
  v_mfma_f32_16x16x32_bf16 v[60:63], v[20:23], v[112:115], v[60:63]
  ds_read_b64_tr_b16 v[44:45], v4 offset:15376
  ds_read_b64_tr_b16 v[46:47], v4 offset:16656
  v_mfma_f32_16x16x32_bf16 v[80:83], v[20:23], v[116:119], v[80:83]
  ds_read_b64_tr_b16 v[48:49], v4 offset:15384
  ds_read_b64_tr_b16 v[50:51], v4 offset:16664
  v_mfma_f32_16x16x32_bf16 v[64:67], v[24:27], v[112:115], v[64:67]
  ds_read_b64_tr_b16 v[52:53], v4 offset:15392
  ds_read_b64_tr_b16 v[54:55], v4 offset:16672
  v_mfma_f32_16x16x32_bf16 v[84:87], v[24:27], v[116:119], v[84:87]
  v_mfma_f32_16x16x32_bf16 v[68:71], v[28:31], v[112:115], v[68:71]
  v_mfma_f32_16x16x32_bf16 v[88:91], v[28:31], v[116:119], v[88:91]
  v_mfma_f32_16x16x32_bf16 v[72:75], v[32:35], v[112:115], v[72:75]
  v_mfma_f32_16x16x32_bf16 v[92:95], v[32:35], v[116:119], v[92:95]
  s_waitcnt vmcnt(12)
  v_max3_u32 v7, v120, v121, v122
  v_max3_u32 v9, v123, v124, v125
  v_max3_u32 v7, v126, v127, v7
  v_max_u32 v7, v7, v9
  v_cmp_eq_u32 vcc, -1, v7
  buffer_load_dwordx4 v[112:115], v2, s[8:11], s64 offen offset:2048 sc1
  buffer_load_dwordx4 v[116:119], v2, s[8:11], s65 offen offset:2048 sc1
  s_cbranch_vccnz P3_RT3
P3_OK3:
  s_waitcnt lgkmcnt(0)
  v_mfma_f32_16x16x32_bf16 v[56:59], v[36:39], v[120:123], v[56:59]
  ds_read_b64_tr_b16 v[16:17], v4 offset:20480
  ds_read_b64_tr_b16 v[18:19], v4 offset:21760
  v_mfma_f32_16x16x32_bf16 v[76:79], v[36:39], v[124:127], v[76:79]
  ds_read_b64_tr_b16 v[20:21], v4 offset:20488
  ds_read_b64_tr_b16 v[22:23], v4 offset:21768
  v_mfma_f32_16x16x32_bf16 v[60:63], v[40:43], v[120:123], v[60:63]
  ds_read_b64_tr_b16 v[24:25], v4 offset:20496
  ds_read_b64_tr_b16 v[26:27], v4 offset:21776
  v_mfma_f32_16x16x32_bf16 v[80:83], v[40:43], v[124:127], v[80:83]
  ds_read_b64_tr_b16 v[28:29], v4 offset:20504
  ds_read_b64_tr_b16 v[30:31], v4 offset:21784
  v_mfma_f32_16x16x32_bf16 v[64:67], v[44:47], v[120:123], v[64:67]
  ds_read_b64_tr_b16 v[32:33], v4 offset:20512
  ds_read_b64_tr_b16 v[34:35], v4 offset:21792
  v_mfma_f32_16x16x32_bf16 v[84:87], v[44:47], v[124:127], v[84:87]
  v_mfma_f32_16x16x32_bf16 v[68:71], v[48:51], v[120:123], v[68:71]
  v_mfma_f32_16x16x32_bf16 v[88:91], v[48:51], v[124:127], v[88:91]
  v_mfma_f32_16x16x32_bf16 v[72:75], v[52:55], v[120:123], v[72:75]
  v_mfma_f32_16x16x32_bf16 v[92:95], v[52:55], v[124:127], v[92:95]
  s_waitcnt vmcnt(12)
  v_max3_u32 v7, v128, v129, v130
  v_max3_u32 v9, v131, v132, v133
  v_max3_u32 v7, v134, v135, v7
  v_max_u32 v7, v7, v9
  v_cmp_eq_u32 vcc, -1, v7
  buffer_load_dwordx4 v[120:123], v2, s[8:11], s64 offen offset:3072 sc1
  buffer_load_dwordx4 v[124:127], v2, s[8:11], s65 offen offset:3072 sc1
  s_cbranch_vccnz P3_RT4
P3_OK4:
  s_waitcnt lgkmcnt(0)
  v_mfma_f32_16x16x32_bf16 v[56:59], v[16:19], v[128:131], v[56:59]
  ds_read_b64_tr_b16 v[36:37], v4 offset:25600
  ds_read_b64_tr_b16 v[38:39], v4 offset:26880
  v_mfma_f32_16x16x32_bf16 v[76:79], v[16:19], v[132:135], v[76:79]
  ds_read_b64_tr_b16 v[40:41], v4 offset:25608
  ds_read_b64_tr_b16 v[42:43], v4 offset:26888
  v_mfma_f32_16x16x32_bf16 v[60:63], v[20:23], v[128:131], v[60:63]
  ds_read_b64_tr_b16 v[44:45], v4 offset:25616
  ds_read_b64_tr_b16 v[46:47], v4 offset:26896
  v_mfma_f32_16x16x32_bf16 v[80:83], v[20:23], v[132:135], v[80:83]
  ds_read_b64_tr_b16 v[48:49], v4 offset:25624
  ds_read_b64_tr_b16 v[50:51], v4 offset:26904
  v_mfma_f32_16x16x32_bf16 v[64:67], v[24:27], v[128:131], v[64:67]
  ds_read_b64_tr_b16 v[52:53], v4 offset:25632
  ds_read_b64_tr_b16 v[54:55], v4 offset:26912
  v_mfma_f32_16x16x32_bf16 v[84:87], v[24:27], v[132:135], v[84:87]
  v_mfma_f32_16x16x32_bf16 v[68:71], v[28:31], v[128:131], v[68:71]
  v_mfma_f32_16x16x32_bf16 v[88:91], v[28:31], v[132:135], v[88:91]
  v_mfma_f32_16x16x32_bf16 v[72:75], v[32:35], v[128:131], v[72:75]
  v_mfma_f32_16x16x32_bf16 v[92:95], v[32:35], v[132:135], v[92:95]
  s_waitcnt vmcnt(12)
  v_max3_u32 v7, v136, v137, v138
  v_max3_u32 v9, v139, v140, v141
  v_max3_u32 v7, v142, v143, v7
  v_max_u32 v7, v7, v9
  v_cmp_eq_u32 vcc, -1, v7
  buffer_load_dwordx4 v[128:131], v2, s[8:11], s66 offen offset:0 sc1
  buffer_load_dwordx4 v[132:135], v2, s[8:11], s67 offen offset:0 sc1
  s_cbranch_vccnz P3_RT5
P3_OK5:
  s_waitcnt lgkmcnt(0)
  v_mfma_f32_16x16x32_bf16 v[56:59], v[36:39], v[136:139], v[56:59]
  ds_read_b64_tr_b16 v[16:17], v4 offset:30720
  ds_read_b64_tr_b16 v[18:19], v4 offset:32000
  v_mfma_f32_16x16x32_bf16 v[76:79], v[36:39], v[140:143], v[76:79]
  ds_read_b64_tr_b16 v[20:21], v4 offset:30728
  ds_read_b64_tr_b16 v[22:23], v4 offset:32008
  v_mfma_f32_16x16x32_bf16 v[60:63], v[40:43], v[136:139], v[60:63]
  ds_read_b64_tr_b16 v[24:25], v4 offset:30736
  ds_read_b64_tr_b16 v[26:27], v4 offset:32016
  v_mfma_f32_16x16x32_bf16 v[80:83], v[40:43], v[140:143], v[80:83]
  ds_read_b64_tr_b16 v[28:29], v4 offset:30744
  ds_read_b64_tr_b16 v[30:31], v4 offset:32024
  v_mfma_f32_16x16x32_bf16 v[64:67], v[44:47], v[136:139], v[64:67]
  ds_read_b64_tr_b16 v[32:33], v4 offset:30752
  ds_read_b64_tr_b16 v[34:35], v4 offset:32032
  v_mfma_f32_16x16x32_bf16 v[84:87], v[44:47], v[140:143], v[84:87]
  v_mfma_f32_16x16x32_bf16 v[68:71], v[48:51], v[136:139], v[68:71]
  v_mfma_f32_16x16x32_bf16 v[88:91], v[48:51], v[140:143], v[88:91]
  v_mfma_f32_16x16x32_bf16 v[72:75], v[52:55], v[136:139], v[72:75]
  v_mfma_f32_16x16x32_bf16 v[92:95], v[52:55], v[140:143], v[92:95]
  s_waitcnt vmcnt(12)
  v_max3_u32 v7, v144, v145, v146
  v_max3_u32 v9, v147, v148, v149
  v_max3_u32 v7, v150, v151, v7
  v_max_u32 v7, v7, v9
  v_cmp_eq_u32 vcc, -1, v7
  buffer_load_dwordx4 v[136:139], v2, s[8:11], s66 offen offset:1024 sc1
  buffer_load_dwordx4 v[140:143], v2, s[8:11], s67 offen offset:1024 sc1
  s_cbranch_vccnz P3_RT6
P3_OK6:
  s_waitcnt lgkmcnt(0)
  v_mfma_f32_16x16x32_bf16 v[56:59], v[16:19], v[144:147], v[56:59]
  ds_read_b64_tr_b16 v[36:37], v4 offset:35840
  ds_read_b64_tr_b16 v[38:39], v4 offset:37120
  v_mfma_f32_16x16x32_bf16 v[76:79], v[16:19], v[148:151], v[76:79]
  ds_read_b64_tr_b16 v[40:41], v4 offset:35848
  ds_read_b64_tr_b16 v[42:43], v4 offset:37128
  v_mfma_f32_16x16x32_bf16 v[60:63], v[20:23], v[144:147], v[60:63]
  ds_read_b64_tr_b16 v[44:45], v4 offset:35856
  ds_read_b64_tr_b16 v[46:47], v4 offset:37136
  v_mfma_f32_16x16x32_bf16 v[80:83], v[20:23], v[148:151], v[80:83]
  ds_read_b64_tr_b16 v[48:49], v4 offset:35864
  ds_read_b64_tr_b16 v[50:51], v4 offset:37144
  v_mfma_f32_16x16x32_bf16 v[64:67], v[24:27], v[144:147], v[64:67]
  ds_read_b64_tr_b16 v[52:53], v4 offset:35872
  ds_read_b64_tr_b16 v[54:55], v4 offset:37152
  v_mfma_f32_16x16x32_bf16 v[84:87], v[24:27], v[148:151], v[84:87]
  v_mfma_f32_16x16x32_bf16 v[68:71], v[28:31], v[144:147], v[68:71]
  v_mfma_f32_16x16x32_bf16 v[88:91], v[28:31], v[148:151], v[88:91]
  v_mfma_f32_16x16x32_bf16 v[72:75], v[32:35], v[144:147], v[72:75]
  v_mfma_f32_16x16x32_bf16 v[92:95], v[32:35], v[148:151], v[92:95]
  s_waitcnt vmcnt(12)
  v_max3_u32 v7, v152, v153, v154
  v_max3_u32 v9, v155, v156, v157
  v_max3_u32 v7, v158, v159, v7
  v_max_u32 v7, v7, v9
  v_cmp_eq_u32 vcc, -1, v7
  buffer_load_dwordx4 v[144:147], v2, s[8:11], s66 offen offset:2048 sc1
  buffer_load_dwordx4 v[148:151], v2, s[8:11], s67 offen offset:2048 sc1
  s_cbranch_vccnz P3_RT7
P3_OK7:
  s_waitcnt lgkmcnt(0)
  v_mfma_f32_16x16x32_bf16 v[56:59], v[36:39], v[152:155], v[56:59]
  ds_read_b64_tr_b16 v[16:17], v4 offset:40960
  ds_read_b64_tr_b16 v[18:19], v4 offset:42240
  v_mfma_f32_16x16x32_bf16 v[76:79], v[36:39], v[156:159], v[76:79]
  ds_read_b64_tr_b16 v[20:21], v4 offset:40968
  ds_read_b64_tr_b16 v[22:23], v4 offset:42248
  v_mfma_f32_16x16x32_bf16 v[60:63], v[40:43], v[152:155], v[60:63]
  ds_read_b64_tr_b16 v[24:25], v4 offset:40976
  ds_read_b64_tr_b16 v[26:27], v4 offset:42256
  v_mfma_f32_16x16x32_bf16 v[80:83], v[40:43], v[156:159], v[80:83]
  ds_read_b64_tr_b16 v[28:29], v4 offset:40984
  ds_read_b64_tr_b16 v[30:31], v4 offset:42264
  v_mfma_f32_16x16x32_bf16 v[64:67], v[44:47], v[152:155], v[64:67]
  ds_read_b64_tr_b16 v[32:33], v4 offset:40992
  ds_read_b64_tr_b16 v[34:35], v4 offset:42272
  v_mfma_f32_16x16x32_bf16 v[84:87], v[44:47], v[156:159], v[84:87]
  v_mfma_f32_16x16x32_bf16 v[68:71], v[48:51], v[152:155], v[68:71]
  v_mfma_f32_16x16x32_bf16 v[88:91], v[48:51], v[156:159], v[88:91]
  v_mfma_f32_16x16x32_bf16 v[72:75], v[52:55], v[152:155], v[72:75]
  v_mfma_f32_16x16x32_bf16 v[92:95], v[52:55], v[156:159], v[92:95]
  s_waitcnt vmcnt(12)
  v_max3_u32 v7, v96, v97, v98
  v_max3_u32 v9, v99, v100, v101
  v_max3_u32 v7, v102, v103, v7
  v_max_u32 v7, v7, v9
  v_cmp_eq_u32 vcc, -1, v7
  buffer_load_dwordx4 v[152:155], v2, s[8:11], s66 offen offset:3072 sc1
  buffer_load_dwordx4 v[156:159], v2, s[8:11], s67 offen offset:3072 sc1
  s_cbranch_vccnz P3_RT8
P3_OK8:
  s_waitcnt lgkmcnt(0)
  v_mfma_f32_16x16x32_bf16 v[56:59], v[16:19], v[96:99], v[56:59]
  ds_read_b64_tr_b16 v[36:37], v4 offset:46080
  ds_read_b64_tr_b16 v[38:39], v4 offset:47360
  v_mfma_f32_16x16x32_bf16 v[76:79], v[16:19], v[100:103], v[76:79]
  ds_read_b64_tr_b16 v[40:41], v4 offset:46088
  ds_read_b64_tr_b16 v[42:43], v4 offset:47368
  v_mfma_f32_16x16x32_bf16 v[60:63], v[20:23], v[96:99], v[60:63]
  ds_read_b64_tr_b16 v[44:45], v4 offset:46096
  ds_read_b64_tr_b16 v[46:47], v4 offset:47376
  v_mfma_f32_16x16x32_bf16 v[80:83], v[20:23], v[100:103], v[80:83]
  ds_read_b64_tr_b16 v[48:49], v4 offset:46104
  ds_read_b64_tr_b16 v[50:51], v4 offset:47384
  v_mfma_f32_16x16x32_bf16 v[64:67], v[24:27], v[96:99], v[64:67]
  ds_read_b64_tr_b16 v[52:53], v4 offset:46112
  ds_read_b64_tr_b16 v[54:55], v4 offset:47392
  v_mfma_f32_16x16x32_bf16 v[84:87], v[24:27], v[100:103], v[84:87]
  v_mfma_f32_16x16x32_bf16 v[68:71], v[28:31], v[96:99], v[68:71]
  v_mfma_f32_16x16x32_bf16 v[88:91], v[28:31], v[100:103], v[88:91]
  v_mfma_f32_16x16x32_bf16 v[72:75], v[32:35], v[96:99], v[72:75]
  v_mfma_f32_16x16x32_bf16 v[92:95], v[32:35], v[100:103], v[92:95]
  s_waitcnt vmcnt(12)
  v_max3_u32 v7, v104, v105, v106
  v_max3_u32 v9, v107, v108, v109
  v_max3_u32 v7, v110, v111, v7
  v_max_u32 v7, v7, v9
  v_cmp_eq_u32 vcc, -1, v7
  buffer_load_dwordx4 v[96:99], v2, s[8:11], s68 offen offset:0 sc1
  buffer_load_dwordx4 v[100:103], v2, s[8:11], s69 offen offset:0 sc1
  s_cbranch_vccnz P3_RT9
P3_OK9:
  s_waitcnt lgkmcnt(0)
  v_mfma_f32_16x16x32_bf16 v[56:59], v[36:39], v[104:107], v[56:59]
  ds_read_b64_tr_b16 v[16:17], v5 offset:0
  ds_read_b64_tr_b16 v[18:19], v5 offset:1280
  v_mfma_f32_16x16x32_bf16 v[76:79], v[36:39], v[108:111], v[76:79]
  ds_read_b64_tr_b16 v[20:21], v5 offset:8
  ds_read_b64_tr_b16 v[22:23], v5 offset:1288
  v_mfma_f32_16x16x32_bf16 v[60:63], v[40:43], v[104:107], v[60:63]
  ds_read_b64_tr_b16 v[24:25], v5 offset:16
  ds_read_b64_tr_b16 v[26:27], v5 offset:1296
  v_mfma_f32_16x16x32_bf16 v[80:83], v[40:43], v[108:111], v[80:83]
  ds_read_b64_tr_b16 v[28:29], v5 offset:24
  ds_read_b64_tr_b16 v[30:31], v5 offset:1304
  v_mfma_f32_16x16x32_bf16 v[64:67], v[44:47], v[104:107], v[64:67]
  ds_read_b64_tr_b16 v[32:33], v5 offset:32
  ds_read_b64_tr_b16 v[34:35], v5 offset:1312
  v_mfma_f32_16x16x32_bf16 v[84:87], v[44:47], v[108:111], v[84:87]
  v_mfma_f32_16x16x32_bf16 v[68:71], v[48:51], v[104:107], v[68:71]
  v_mfma_f32_16x16x32_bf16 v[88:91], v[48:51], v[108:111], v[88:91]
  v_mfma_f32_16x16x32_bf16 v[72:75], v[52:55], v[104:107], v[72:75]
  v_mfma_f32_16x16x32_bf16 v[92:95], v[52:55], v[108:111], v[92:95]
  s_waitcnt vmcnt(12)
  v_max3_u32 v7, v112, v113, v114
  v_max3_u32 v9, v115, v116, v117
  v_max3_u32 v7, v118, v119, v7
  v_max_u32 v7, v7, v9
  v_cmp_eq_u32 vcc, -1, v7
  buffer_load_dwordx4 v[104:107], v2, s[8:11], s68 offen offset:1024 sc1
  buffer_load_dwordx4 v[108:111], v2, s[8:11], s69 offen offset:1024 sc1
  s_cbranch_vccnz P3_RT10
P3_OK10:
  s_waitcnt lgkmcnt(0)
  v_mfma_f32_16x16x32_bf16 v[56:59], v[16:19], v[112:115], v[56:59]
  ds_read_b64_tr_b16 v[36:37], v5 offset:5120
  ds_read_b64_tr_b16 v[38:39], v5 offset:6400
  v_mfma_f32_16x16x32_bf16 v[76:79], v[16:19], v[116:119], v[76:79]
  ds_read_b64_tr_b16 v[40:41], v5 offset:5128
  ds_read_b64_tr_b16 v[42:43], v5 offset:6408
  v_mfma_f32_16x16x32_bf16 v[60:63], v[20:23], v[112:115], v[60:63]
  ds_read_b64_tr_b16 v[44:45], v5 offset:5136
  ds_read_b64_tr_b16 v[46:47], v5 offset:6416
  v_mfma_f32_16x16x32_bf16 v[80:83], v[20:23], v[116:119], v[80:83]
  ds_read_b64_tr_b16 v[48:49], v5 offset:5144
  ds_read_b64_tr_b16 v[50:51], v5 offset:6424
  v_mfma_f32_16x16x32_bf16 v[64:67], v[24:27], v[112:115], v[64:67]
  ds_read_b64_tr_b16 v[52:53], v5 offset:5152
  ds_read_b64_tr_b16 v[54:55], v5 offset:6432
  v_mfma_f32_16x16x32_bf16 v[84:87], v[24:27], v[116:119], v[84:87]
  v_mfma_f32_16x16x32_bf16 v[68:71], v[28:31], v[112:115], v[68:71]
  v_mfma_f32_16x16x32_bf16 v[88:91], v[28:31], v[116:119], v[88:91]
  v_mfma_f32_16x16x32_bf16 v[72:75], v[32:35], v[112:115], v[72:75]
  v_mfma_f32_16x16x32_bf16 v[92:95], v[32:35], v[116:119], v[92:95]
  s_waitcnt vmcnt(12)
  v_max3_u32 v7, v120, v121, v122
  v_max3_u32 v9, v123, v124, v125
  v_max3_u32 v7, v126, v127, v7
  v_max_u32 v7, v7, v9
  v_cmp_eq_u32 vcc, -1, v7
  buffer_load_dwordx4 v[112:115], v2, s[8:11], s68 offen offset:2048 sc1
  buffer_load_dwordx4 v[116:119], v2, s[8:11], s69 offen offset:2048 sc1
  s_cbranch_vccnz P3_RT11
P3_OK11:
  s_waitcnt lgkmcnt(0)
  v_mfma_f32_16x16x32_bf16 v[56:59], v[36:39], v[120:123], v[56:59]
  ds_read_b64_tr_b16 v[16:17], v5 offset:10240
  ds_read_b64_tr_b16 v[18:19], v5 offset:11520
  v_mfma_f32_16x16x32_bf16 v[76:79], v[36:39], v[124:127], v[76:79]
  ds_read_b64_tr_b16 v[20:21], v5 offset:10248
  ds_read_b64_tr_b16 v[22:23], v5 offset:11528
  v_mfma_f32_16x16x32_bf16 v[60:63], v[40:43], v[120:123], v[60:63]
  ds_read_b64_tr_b16 v[24:25], v5 offset:10256
  ds_read_b64_tr_b16 v[26:27], v5 offset:11536
  v_mfma_f32_16x16x32_bf16 v[80:83], v[40:43], v[124:127], v[80:83]
  ds_read_b64_tr_b16 v[28:29], v5 offset:10264
  ds_read_b64_tr_b16 v[30:31], v5 offset:11544
  v_mfma_f32_16x16x32_bf16 v[64:67], v[44:47], v[120:123], v[64:67]
  ds_read_b64_tr_b16 v[32:33], v5 offset:10272
  ds_read_b64_tr_b16 v[34:35], v5 offset:11552
  v_mfma_f32_16x16x32_bf16 v[84:87], v[44:47], v[124:127], v[84:87]
  v_mfma_f32_16x16x32_bf16 v[68:71], v[48:51], v[120:123], v[68:71]
  v_mfma_f32_16x16x32_bf16 v[88:91], v[48:51], v[124:127], v[88:91]
  v_mfma_f32_16x16x32_bf16 v[72:75], v[52:55], v[120:123], v[72:75]
  v_mfma_f32_16x16x32_bf16 v[92:95], v[52:55], v[124:127], v[92:95]
  s_waitcnt vmcnt(12)
  v_max3_u32 v7, v128, v129, v130
  v_max3_u32 v9, v131, v132, v133
  v_max3_u32 v7, v134, v135, v7
  v_max_u32 v7, v7, v9
  v_cmp_eq_u32 vcc, -1, v7
  buffer_load_dwordx4 v[120:123], v2, s[8:11], s68 offen offset:3072 sc1
  buffer_load_dwordx4 v[124:127], v2, s[8:11], s69 offen offset:3072 sc1
  s_cbranch_vccnz P3_RT12
P3_OK12:
  s_waitcnt lgkmcnt(0)
  v_mfma_f32_16x16x32_bf16 v[56:59], v[16:19], v[128:131], v[56:59]
  ds_read_b64_tr_b16 v[36:37], v5 offset:15360
  ds_read_b64_tr_b16 v[38:39], v5 offset:16640
  v_mfma_f32_16x16x32_bf16 v[76:79], v[16:19], v[132:135], v[76:79]
  ds_read_b64_tr_b16 v[40:41], v5 offset:15368
  ds_read_b64_tr_b16 v[42:43], v5 offset:16648
  v_mfma_f32_16x16x32_bf16 v[60:63], v[20:23], v[128:131], v[60:63]
  ds_read_b64_tr_b16 v[44:45], v5 offset:15376
  ds_read_b64_tr_b16 v[46:47], v5 offset:16656
  v_mfma_f32_16x16x32_bf16 v[80:83], v[20:23], v[132:135], v[80:83]
  ds_read_b64_tr_b16 v[48:49], v5 offset:15384
  ds_read_b64_tr_b16 v[50:51], v5 offset:16664
  v_mfma_f32_16x16x32_bf16 v[64:67], v[24:27], v[128:131], v[64:67]
  ds_read_b64_tr_b16 v[52:53], v5 offset:15392
  ds_read_b64_tr_b16 v[54:55], v5 offset:16672
  v_mfma_f32_16x16x32_bf16 v[84:87], v[24:27], v[132:135], v[84:87]
  v_mfma_f32_16x16x32_bf16 v[68:71], v[28:31], v[128:131], v[68:71]
  v_mfma_f32_16x16x32_bf16 v[88:91], v[28:31], v[132:135], v[88:91]
  v_mfma_f32_16x16x32_bf16 v[72:75], v[32:35], v[128:131], v[72:75]
  v_mfma_f32_16x16x32_bf16 v[92:95], v[32:35], v[132:135], v[92:95]
  s_waitcnt vmcnt(12)
  v_max3_u32 v7, v136, v137, v138
  v_max3_u32 v9, v139, v140, v141
  v_max3_u32 v7, v142, v143, v7
  v_max_u32 v7, v7, v9
  v_cmp_eq_u32 vcc, -1, v7
  s_nop 1
  s_cbranch_vccnz P3_RT13
P3_OK13:
  s_waitcnt lgkmcnt(0)
  v_mfma_f32_16x16x32_bf16 v[56:59], v[36:39], v[136:139], v[56:59]
  ds_read_b64_tr_b16 v[16:17], v5 offset:20480
  ds_read_b64_tr_b16 v[18:19], v5 offset:21760
  v_mfma_f32_16x16x32_bf16 v[76:79], v[36:39], v[140:143], v[76:79]
  ds_read_b64_tr_b16 v[20:21], v5 offset:20488
  ds_read_b64_tr_b16 v[22:23], v5 offset:21768
  v_mfma_f32_16x16x32_bf16 v[60:63], v[40:43], v[136:139], v[60:63]
  ds_read_b64_tr_b16 v[24:25], v5 offset:20496
  ds_read_b64_tr_b16 v[26:27], v5 offset:21776
  v_mfma_f32_16x16x32_bf16 v[80:83], v[40:43], v[140:143], v[80:83]
  ds_read_b64_tr_b16 v[28:29], v5 offset:20504
  ds_read_b64_tr_b16 v[30:31], v5 offset:21784
  v_mfma_f32_16x16x32_bf16 v[64:67], v[44:47], v[136:139], v[64:67]
  ds_read_b64_tr_b16 v[32:33], v5 offset:20512
  ds_read_b64_tr_b16 v[34:35], v5 offset:21792
  v_mfma_f32_16x16x32_bf16 v[84:87], v[44:47], v[140:143], v[84:87]
  v_mfma_f32_16x16x32_bf16 v[68:71], v[48:51], v[136:139], v[68:71]
  v_mfma_f32_16x16x32_bf16 v[88:91], v[48:51], v[140:143], v[88:91]
  v_mfma_f32_16x16x32_bf16 v[72:75], v[52:55], v[136:139], v[72:75]
  v_mfma_f32_16x16x32_bf16 v[92:95], v[52:55], v[140:143], v[92:95]
  s_waitcnt vmcnt(10)
  v_max3_u32 v7, v144, v145, v146
  v_max3_u32 v9, v147, v148, v149
  v_max3_u32 v7, v150, v151, v7
  v_max_u32 v7, v7, v9
  v_cmp_eq_u32 vcc, -1, v7
  s_nop 1
  s_cbranch_vccnz P3_RT14
P3_OK14:
  s_waitcnt lgkmcnt(0)
  v_mfma_f32_16x16x32_bf16 v[56:59], v[16:19], v[144:147], v[56:59]
  ds_read_b64_tr_b16 v[36:37], v5 offset:25600
  ds_read_b64_tr_b16 v[38:39], v5 offset:26880
  v_mfma_f32_16x16x32_bf16 v[76:79], v[16:19], v[148:151], v[76:79]
  ds_read_b64_tr_b16 v[40:41], v5 offset:25608
  ds_read_b64_tr_b16 v[42:43], v5 offset:26888
  v_mfma_f32_16x16x32_bf16 v[60:63], v[20:23], v[144:147], v[60:63]
  ds_read_b64_tr_b16 v[44:45], v5 offset:25616
  ds_read_b64_tr_b16 v[46:47], v5 offset:26896
  v_mfma_f32_16x16x32_bf16 v[80:83], v[20:23], v[148:151], v[80:83]
  ds_read_b64_tr_b16 v[48:49], v5 offset:25624
  ds_read_b64_tr_b16 v[50:51], v5 offset:26904
  v_mfma_f32_16x16x32_bf16 v[64:67], v[24:27], v[144:147], v[64:67]
  ds_read_b64_tr_b16 v[52:53], v5 offset:25632
  ds_read_b64_tr_b16 v[54:55], v5 offset:26912
  v_mfma_f32_16x16x32_bf16 v[84:87], v[24:27], v[148:151], v[84:87]
  v_mfma_f32_16x16x32_bf16 v[68:71], v[28:31], v[144:147], v[68:71]
  v_mfma_f32_16x16x32_bf16 v[88:91], v[28:31], v[148:151], v[88:91]
  v_mfma_f32_16x16x32_bf16 v[72:75], v[32:35], v[144:147], v[72:75]
  v_mfma_f32_16x16x32_bf16 v[92:95], v[32:35], v[148:151], v[92:95]
  s_waitcnt vmcnt(8)
  v_max3_u32 v7, v152, v153, v154
  v_max3_u32 v9, v155, v156, v157
  v_max3_u32 v7, v158, v159, v7
  v_max_u32 v7, v7, v9
  v_cmp_eq_u32 vcc, -1, v7
  s_nop 1
  s_cbranch_vccnz P3_RT15
P3_OK15:
  s_waitcnt lgkmcnt(0)
  v_mfma_f32_16x16x32_bf16 v[56:59], v[36:39], v[152:155], v[56:59]
  ds_read_b64_tr_b16 v[16:17], v5 offset:30720
  ds_read_b64_tr_b16 v[18:19], v5 offset:32000
  v_mfma_f32_16x16x32_bf16 v[76:79], v[36:39], v[156:159], v[76:79]
  ds_read_b64_tr_b16 v[20:21], v5 offset:30728
  ds_read_b64_tr_b16 v[22:23], v5 offset:32008
  v_mfma_f32_16x16x32_bf16 v[60:63], v[40:43], v[152:155], v[60:63]
  ds_read_b64_tr_b16 v[24:25], v5 offset:30736
  ds_read_b64_tr_b16 v[26:27], v5 offset:32016
  v_mfma_f32_16x16x32_bf16 v[80:83], v[40:43], v[156:159], v[80:83]
  ds_read_b64_tr_b16 v[28:29], v5 offset:30744
  ds_read_b64_tr_b16 v[30:31], v5 offset:32024
  v_mfma_f32_16x16x32_bf16 v[64:67], v[44:47], v[152:155], v[64:67]
  ds_read_b64_tr_b16 v[32:33], v5 offset:30752
  ds_read_b64_tr_b16 v[34:35], v5 offset:32032
  v_mfma_f32_16x16x32_bf16 v[84:87], v[44:47], v[156:159], v[84:87]
  v_mfma_f32_16x16x32_bf16 v[68:71], v[48:51], v[152:155], v[68:71]
  v_mfma_f32_16x16x32_bf16 v[88:91], v[48:51], v[156:159], v[88:91]
  v_mfma_f32_16x16x32_bf16 v[72:75], v[52:55], v[152:155], v[72:75]
  v_mfma_f32_16x16x32_bf16 v[92:95], v[52:55], v[156:159], v[92:95]
  s_waitcnt vmcnt(6)
  v_max3_u32 v7, v96, v97, v98
  v_max3_u32 v9, v99, v100, v101
  v_max3_u32 v7, v102, v103, v7
  v_max_u32 v7, v7, v9
  v_cmp_eq_u32 vcc, -1, v7
  s_nop 1
  s_cbranch_vccnz P3_RT16
P3_OK16:
  s_waitcnt lgkmcnt(0)
  v_mfma_f32_16x16x32_bf16 v[56:59], v[16:19], v[96:99], v[56:59]
  ds_read_b64_tr_b16 v[36:37], v5 offset:35840
  ds_read_b64_tr_b16 v[38:39], v5 offset:37120
  v_mfma_f32_16x16x32_bf16 v[76:79], v[16:19], v[100:103], v[76:79]
  ds_read_b64_tr_b16 v[40:41], v5 offset:35848
  ds_read_b64_tr_b16 v[42:43], v5 offset:37128
  v_mfma_f32_16x16x32_bf16 v[60:63], v[20:23], v[96:99], v[60:63]
  ds_read_b64_tr_b16 v[44:45], v5 offset:35856
  ds_read_b64_tr_b16 v[46:47], v5 offset:37136
  v_mfma_f32_16x16x32_bf16 v[80:83], v[20:23], v[100:103], v[80:83]
  ds_read_b64_tr_b16 v[48:49], v5 offset:35864
  ds_read_b64_tr_b16 v[50:51], v5 offset:37144
  v_mfma_f32_16x16x32_bf16 v[64:67], v[24:27], v[96:99], v[64:67]
  ds_read_b64_tr_b16 v[52:53], v5 offset:35872
  ds_read_b64_tr_b16 v[54:55], v5 offset:37152
  v_mfma_f32_16x16x32_bf16 v[84:87], v[24:27], v[100:103], v[84:87]
  v_mfma_f32_16x16x32_bf16 v[68:71], v[28:31], v[96:99], v[68:71]
  v_mfma_f32_16x16x32_bf16 v[88:91], v[28:31], v[100:103], v[88:91]
  v_mfma_f32_16x16x32_bf16 v[72:75], v[32:35], v[96:99], v[72:75]
  v_mfma_f32_16x16x32_bf16 v[92:95], v[32:35], v[100:103], v[92:95]
  s_waitcnt vmcnt(4)
  v_max3_u32 v7, v104, v105, v106
  v_max3_u32 v9, v107, v108, v109
  v_max3_u32 v7, v110, v111, v7
  v_max_u32 v7, v7, v9
  v_cmp_eq_u32 vcc, -1, v7
  s_nop 1
  s_cbranch_vccnz P3_RT17
P3_OK17:
  s_waitcnt lgkmcnt(0)
  v_mfma_f32_16x16x32_bf16 v[56:59], v[36:39], v[104:107], v[56:59]
  ds_read_b64_tr_b16 v[16:17], v5 offset:40960
  ds_read_b64_tr_b16 v[18:19], v5 offset:42240
  v_mfma_f32_16x16x32_bf16 v[76:79], v[36:39], v[108:111], v[76:79]
  ds_read_b64_tr_b16 v[20:21], v5 offset:40968
  ds_read_b64_tr_b16 v[22:23], v5 offset:42248
  v_mfma_f32_16x16x32_bf16 v[60:63], v[40:43], v[104:107], v[60:63]
  ds_read_b64_tr_b16 v[24:25], v5 offset:40976
  ds_read_b64_tr_b16 v[26:27], v5 offset:42256
  v_mfma_f32_16x16x32_bf16 v[80:83], v[40:43], v[108:111], v[80:83]
  ds_read_b64_tr_b16 v[28:29], v5 offset:40984
  ds_read_b64_tr_b16 v[30:31], v5 offset:42264
  v_mfma_f32_16x16x32_bf16 v[64:67], v[44:47], v[104:107], v[64:67]
  ds_read_b64_tr_b16 v[32:33], v5 offset:40992
  ds_read_b64_tr_b16 v[34:35], v5 offset:42272
  v_mfma_f32_16x16x32_bf16 v[84:87], v[44:47], v[108:111], v[84:87]
  v_mfma_f32_16x16x32_bf16 v[68:71], v[48:51], v[104:107], v[68:71]
  v_mfma_f32_16x16x32_bf16 v[88:91], v[48:51], v[108:111], v[88:91]
  v_mfma_f32_16x16x32_bf16 v[72:75], v[52:55], v[104:107], v[72:75]
  v_mfma_f32_16x16x32_bf16 v[92:95], v[52:55], v[108:111], v[92:95]
  s_waitcnt vmcnt(2)
  v_max3_u32 v7, v112, v113, v114
  v_max3_u32 v9, v115, v116, v117
  v_max3_u32 v7, v118, v119, v7
  v_max_u32 v7, v7, v9
  v_cmp_eq_u32 vcc, -1, v7
  s_nop 1
  s_cbranch_vccnz P3_RT18
P3_OK18:
  s_waitcnt lgkmcnt(0)
  v_mfma_f32_16x16x32_bf16 v[56:59], v[16:19], v[112:115], v[56:59]
  ds_read_b64_tr_b16 v[36:37], v5 offset:46080
  ds_read_b64_tr_b16 v[38:39], v5 offset:47360
  v_mfma_f32_16x16x32_bf16 v[76:79], v[16:19], v[116:119], v[76:79]
  ds_read_b64_tr_b16 v[40:41], v5 offset:46088
  ds_read_b64_tr_b16 v[42:43], v5 offset:47368
  v_mfma_f32_16x16x32_bf16 v[60:63], v[20:23], v[112:115], v[60:63]
  ds_read_b64_tr_b16 v[44:45], v5 offset:46096
  ds_read_b64_tr_b16 v[46:47], v5 offset:47376
  v_mfma_f32_16x16x32_bf16 v[80:83], v[20:23], v[116:119], v[80:83]
  ds_read_b64_tr_b16 v[48:49], v5 offset:46104
  ds_read_b64_tr_b16 v[50:51], v5 offset:47384
  v_mfma_f32_16x16x32_bf16 v[64:67], v[24:27], v[112:115], v[64:67]
  ds_read_b64_tr_b16 v[52:53], v5 offset:46112
  ds_read_b64_tr_b16 v[54:55], v5 offset:47392
  v_mfma_f32_16x16x32_bf16 v[84:87], v[24:27], v[116:119], v[84:87]
  v_mfma_f32_16x16x32_bf16 v[68:71], v[28:31], v[112:115], v[68:71]
  v_mfma_f32_16x16x32_bf16 v[88:91], v[28:31], v[116:119], v[88:91]
  v_mfma_f32_16x16x32_bf16 v[72:75], v[32:35], v[112:115], v[72:75]
  v_mfma_f32_16x16x32_bf16 v[92:95], v[32:35], v[116:119], v[92:95]
  s_waitcnt vmcnt(0)
  v_max3_u32 v7, v120, v121, v122
  v_max3_u32 v9, v123, v124, v125
  v_max3_u32 v7, v126, v127, v7
  v_max_u32 v7, v7, v9
  v_cmp_eq_u32 vcc, -1, v7
  s_nop 1
  s_cbranch_vccnz P3_RT19
P3_OK19:
  s_waitcnt lgkmcnt(0)
  v_mfma_f32_16x16x32_bf16 v[56:59], v[36:39], v[120:123], v[56:59]
  v_mfma_f32_16x16x32_bf16 v[76:79], v[36:39], v[124:127], v[76:79]
  v_mfma_f32_16x16x32_bf16 v[60:63], v[40:43], v[120:123], v[60:63]
  v_mfma_f32_16x16x32_bf16 v[80:83], v[40:43], v[124:127], v[80:83]
  v_mfma_f32_16x16x32_bf16 v[64:67], v[44:47], v[120:123], v[64:67]
  v_mfma_f32_16x16x32_bf16 v[84:87], v[44:47], v[124:127], v[84:87]
  v_mfma_f32_16x16x32_bf16 v[68:71], v[48:51], v[120:123], v[68:71]
  v_mfma_f32_16x16x32_bf16 v[88:91], v[48:51], v[124:127], v[88:91]
  v_mfma_f32_16x16x32_bf16 v[72:75], v[52:55], v[120:123], v[72:75]
  v_mfma_f32_16x16x32_bf16 v[92:95], v[52:55], v[124:127], v[92:95]
  s_nop 7
  v_cvt_pk_bf16_f32 v16, v56, v57
  v_cvt_pk_bf16_f32 v17, v58, v59
  ds_write_b64 v3, v[16:17] offset:0
  v_cvt_pk_bf16_f32 v18, v60, v61
  v_cvt_pk_bf16_f32 v19, v62, v63
  ds_write_b64 v3, v[18:19] offset:8
  v_cvt_pk_bf16_f32 v20, v64, v65
  v_cvt_pk_bf16_f32 v21, v66, v67
  ds_write_b64 v3, v[20:21] offset:16
  v_cvt_pk_bf16_f32 v22, v68, v69
  v_cvt_pk_bf16_f32 v23, v70, v71
  ds_write_b64 v3, v[22:23] offset:24
  v_cvt_pk_bf16_f32 v24, v72, v73
  v_cvt_pk_bf16_f32 v25, v74, v75
  ds_write_b64 v3, v[24:25] offset:32
  v_cvt_pk_bf16_f32 v26, v76, v77
  v_cvt_pk_bf16_f32 v27, v78, v79
  ds_write_b64 v3, v[26:27] offset:2560
  v_cvt_pk_bf16_f32 v28, v80, v81
  v_cvt_pk_bf16_f32 v29, v82, v83
  ds_write_b64 v3, v[28:29] offset:2568
  v_cvt_pk_bf16_f32 v30, v84, v85
  v_cvt_pk_bf16_f32 v31, v86, v87
  ds_write_b64 v3, v[30:31] offset:2576
  v_cvt_pk_bf16_f32 v32, v88, v89
  v_cvt_pk_bf16_f32 v33, v90, v91
  ds_write_b64 v3, v[32:33] offset:2584
  v_cvt_pk_bf16_f32 v34, v92, v93
  v_cvt_pk_bf16_f32 v35, v94, v95
  ds_write_b64 v3, v[34:35] offset:2592
  s_waitcnt lgkmcnt(0)
  ds_read_b128 v[96:99], v15 offset:0
  ds_read_b128 v[100:103], v15 offset:1024
  ds_read_b128 v[104:107], v15 offset:2048
  ds_read_b128 v[108:111], v15 offset:3072
  ds_read_b128 v[112:115], v15 offset:4096
  s_waitcnt lgkmcnt(4)
  buffer_store_dwordx4 v[96:99], v6, s[36:39], s71 offen nt
  s_waitcnt lgkmcnt(3)
  buffer_store_dwordx4 v[100:103], v8, s[36:39], s71 offen nt
  s_waitcnt lgkmcnt(2)
  buffer_store_dwordx4 v[104:107], v12, s[36:39], s71 offen nt
  s_waitcnt lgkmcnt(1)
  buffer_store_dwordx4 v[108:111], v13, s[36:39], s71 offen nt
  s_waitcnt lgkmcnt(0)
  buffer_store_dwordx4 v[112:115], v14, s[36:39], s71 offen nt
KEND:
  s_endpgm
P3_RT0:
  s_waitcnt vmcnt(0)
P3_RL0:
  s_sleep 2
  buffer_load_dwordx4 v[96:99], v2, s[8:11], s60 offen offset:0 sc1
  buffer_load_dwordx4 v[100:103], v2, s[8:11], s61 offen offset:0 sc1
  s_add_u32 s70, s70, 1
  s_waitcnt vmcnt(0)
  v_max3_u32 v7, v96, v97, v98
  v_max3_u32 v9, v99, v100, v101
  v_max3_u32 v7, v102, v103, v7
  v_max_u32 v7, v7, v9
  v_cmp_eq_u32 vcc, -1, v7
  s_cmp_ge_u32 s70, 65536
  s_cbranch_scc1 P3_RD0
  s_cbranch_vccnz P3_RL0
P3_RD0:
  buffer_load_dwordx4 v[104:107], v2, s[8:11], s60 offen offset:1024 sc1
  buffer_load_dwordx4 v[108:111], v2, s[8:11], s61 offen offset:1024 sc1
  buffer_load_dwordx4 v[112:115], v2, s[8:11], s60 offen offset:2048 sc1
  buffer_load_dwordx4 v[116:119], v2, s[8:11], s61 offen offset:2048 sc1
  buffer_load_dwordx4 v[120:123], v2, s[8:11], s60 offen offset:3072 sc1
  buffer_load_dwordx4 v[124:127], v2, s[8:11], s61 offen offset:3072 sc1
  buffer_load_dwordx4 v[128:131], v2, s[8:11], s62 offen offset:0 sc1
  buffer_load_dwordx4 v[132:135], v2, s[8:11], s63 offen offset:0 sc1
  buffer_load_dwordx4 v[136:139], v2, s[8:11], s62 offen offset:1024 sc1
  buffer_load_dwordx4 v[140:143], v2, s[8:11], s63 offen offset:1024 sc1
  buffer_load_dwordx4 v[144:147], v2, s[8:11], s62 offen offset:2048 sc1
  buffer_load_dwordx4 v[148:151], v2, s[8:11], s63 offen offset:2048 sc1
  buffer_load_dwordx4 v[152:155], v2, s[8:11], s62 offen offset:3072 sc1
  buffer_load_dwordx4 v[156:159], v2, s[8:11], s63 offen offset:3072 sc1
  s_branch P3_OK0
P3_RT1:
  s_waitcnt vmcnt(0)
P3_RL1:
  s_sleep 2
  buffer_load_dwordx4 v[104:107], v2, s[8:11], s60 offen offset:1024 sc1
  buffer_load_dwordx4 v[108:111], v2, s[8:11], s61 offen offset:1024 sc1
  s_add_u32 s70, s70, 1
  s_waitcnt vmcnt(0)
  v_max3_u32 v7, v104, v105, v106
  v_max3_u32 v9, v107, v108, v109
  v_max3_u32 v7, v110, v111, v7
  v_max_u32 v7, v7, v9
  v_cmp_eq_u32 vcc, -1, v7
  s_cmp_ge_u32 s70, 65536
  s_cbranch_scc1 P3_RD1
  s_cbranch_vccnz P3_RL1
P3_RD1:
  buffer_load_dwordx4 v[112:115], v2, s[8:11], s60 offen offset:2048 sc1
  buffer_load_dwordx4 v[116:119], v2, s[8:11], s61 offen offset:2048 sc1
  buffer_load_dwordx4 v[120:123], v2, s[8:11], s60 offen offset:3072 sc1
  buffer_load_dwordx4 v[124:127], v2, s[8:11], s61 offen offset:3072 sc1
  buffer_load_dwordx4 v[128:131], v2, s[8:11], s62 offen offset:0 sc1
  buffer_load_dwordx4 v[132:135], v2, s[8:11], s63 offen offset:0 sc1
  buffer_load_dwordx4 v[136:139], v2, s[8:11], s62 offen offset:1024 sc1
  buffer_load_dwordx4 v[140:143], v2, s[8:11], s63 offen offset:1024 sc1
  buffer_load_dwordx4 v[144:147], v2, s[8:11], s62 offen offset:2048 sc1
  buffer_load_dwordx4 v[148:151], v2, s[8:11], s63 offen offset:2048 sc1
  buffer_load_dwordx4 v[152:155], v2, s[8:11], s62 offen offset:3072 sc1
  buffer_load_dwordx4 v[156:159], v2, s[8:11], s63 offen offset:3072 sc1
  buffer_load_dwordx4 v[96:99], v2, s[8:11], s64 offen offset:0 sc1
  buffer_load_dwordx4 v[100:103], v2, s[8:11], s65 offen offset:0 sc1
  s_branch P3_OK1
P3_RT2:
  s_waitcnt vmcnt(0)
P3_RL2:
  s_sleep 2
  buffer_load_dwordx4 v[112:115], v2, s[8:11], s60 offen offset:2048 sc1
  buffer_load_dwordx4 v[116:119], v2, s[8:11], s61 offen offset:2048 sc1
  s_add_u32 s70, s70, 1
  s_waitcnt vmcnt(0)
  v_max3_u32 v7, v112, v113, v114
  v_max3_u32 v9, v115, v116, v117
  v_max3_u32 v7, v118, v119, v7
  v_max_u32 v7, v7, v9
  v_cmp_eq_u32 vcc, -1, v7
  s_cmp_ge_u32 s70, 65536
  s_cbranch_scc1 P3_RD2
  s_cbranch_vccnz P3_RL2
P3_RD2:
  buffer_load_dwordx4 v[120:123], v2, s[8:11], s60 offen offset:3072 sc1
  buffer_load_dwordx4 v[124:127], v2, s[8:11], s61 offen offset:3072 sc1
  buffer_load_dwordx4 v[128:131], v2, s[8:11], s62 offen offset:0 sc1
  buffer_load_dwordx4 v[132:135], v2, s[8:11], s63 offen offset:0 sc1
  buffer_load_dwordx4 v[136:139], v2, s[8:11], s62 offen offset:1024 sc1
  buffer_load_dwordx4 v[140:143], v2, s[8:11], s63 offen offset:1024 sc1
  buffer_load_dwordx4 v[144:147], v2, s[8:11], s62 offen offset:2048 sc1
  buffer_load_dwordx4 v[148:151], v2, s[8:11], s63 offen offset:2048 sc1
  buffer_load_dwordx4 v[152:155], v2, s[8:11], s62 offen offset:3072 sc1
  buffer_load_dwordx4 v[156:159], v2, s[8:11], s63 offen offset:3072 sc1
  buffer_load_dwordx4 v[96:99], v2, s[8:11], s64 offen offset:0 sc1
  buffer_load_dwordx4 v[100:103], v2, s[8:11], s65 offen offset:0 sc1
  buffer_load_dwordx4 v[104:107], v2, s[8:11], s64 offen offset:1024 sc1
  buffer_load_dwordx4 v[108:111], v2, s[8:11], s65 offen offset:1024 sc1
  s_branch P3_OK2
P3_RT3:
  s_waitcnt vmcnt(0)
P3_RL3:
  s_sleep 2
  buffer_load_dwordx4 v[120:123], v2, s[8:11], s60 offen offset:3072 sc1
  buffer_load_dwordx4 v[124:127], v2, s[8:11], s61 offen offset:3072 sc1
  s_add_u32 s70, s70, 1
  s_waitcnt vmcnt(0)
  v_max3_u32 v7, v120, v121, v122
  v_max3_u32 v9, v123, v124, v125
  v_max3_u32 v7, v126, v127, v7
  v_max_u32 v7, v7, v9
  v_cmp_eq_u32 vcc, -1, v7
  s_cmp_ge_u32 s70, 65536
  s_cbranch_scc1 P3_RD3
  s_cbranch_vccnz P3_RL3
P3_RD3:
  buffer_load_dwordx4 v[128:131], v2, s[8:11], s62 offen offset:0 sc1
  buffer_load_dwordx4 v[132:135], v2, s[8:11], s63 offen offset:0 sc1
  buffer_load_dwordx4 v[136:139], v2, s[8:11], s62 offen offset:1024 sc1
  buffer_load_dwordx4 v[140:143], v2, s[8:11], s63 offen offset:1024 sc1
  buffer_load_dwordx4 v[144:147], v2, s[8:11], s62 offen offset:2048 sc1
  buffer_load_dwordx4 v[148:151], v2, s[8:11], s63 offen offset:2048 sc1
  buffer_load_dwordx4 v[152:155], v2, s[8:11], s62 offen offset:3072 sc1
  buffer_load_dwordx4 v[156:159], v2, s[8:11], s63 offen offset:3072 sc1
  buffer_load_dwordx4 v[96:99], v2, s[8:11], s64 offen offset:0 sc1
  buffer_load_dwordx4 v[100:103], v2, s[8:11], s65 offen offset:0 sc1
  buffer_load_dwordx4 v[104:107], v2, s[8:11], s64 offen offset:1024 sc1
  buffer_load_dwordx4 v[108:111], v2, s[8:11], s65 offen offset:1024 sc1
  buffer_load_dwordx4 v[112:115], v2, s[8:11], s64 offen offset:2048 sc1
  buffer_load_dwordx4 v[116:119], v2, s[8:11], s65 offen offset:2048 sc1
  s_branch P3_OK3
P3_RT4:
  s_waitcnt vmcnt(0)
P3_RL4:
  s_sleep 2
  buffer_load_dwordx4 v[128:131], v2, s[8:11], s62 offen offset:0 sc1
  buffer_load_dwordx4 v[132:135], v2, s[8:11], s63 offen offset:0 sc1
  s_add_u32 s70, s70, 1
  s_waitcnt vmcnt(0)
  v_max3_u32 v7, v128, v129, v130
  v_max3_u32 v9, v131, v132, v133
  v_max3_u32 v7, v134, v135, v7
  v_max_u32 v7, v7, v9
  v_cmp_eq_u32 vcc, -1, v7
  s_cmp_ge_u32 s70, 65536
  s_cbranch_scc1 P3_RD4
  s_cbranch_vccnz P3_RL4
P3_RD4:
  buffer_load_dwordx4 v[136:139], v2, s[8:11], s62 offen offset:1024 sc1
  buffer_load_dwordx4 v[140:143], v2, s[8:11], s63 offen offset:1024 sc1
  buffer_load_dwordx4 v[144:147], v2, s[8:11], s62 offen offset:2048 sc1
  buffer_load_dwordx4 v[148:151], v2, s[8:11], s63 offen offset:2048 sc1
  buffer_load_dwordx4 v[152:155], v2, s[8:11], s62 offen offset:3072 sc1
  buffer_load_dwordx4 v[156:159], v2, s[8:11], s63 offen offset:3072 sc1
  buffer_load_dwordx4 v[96:99], v2, s[8:11], s64 offen offset:0 sc1
  buffer_load_dwordx4 v[100:103], v2, s[8:11], s65 offen offset:0 sc1
  buffer_load_dwordx4 v[104:107], v2, s[8:11], s64 offen offset:1024 sc1
  buffer_load_dwordx4 v[108:111], v2, s[8:11], s65 offen offset:1024 sc1
  buffer_load_dwordx4 v[112:115], v2, s[8:11], s64 offen offset:2048 sc1
  buffer_load_dwordx4 v[116:119], v2, s[8:11], s65 offen offset:2048 sc1
  buffer_load_dwordx4 v[120:123], v2, s[8:11], s64 offen offset:3072 sc1
  buffer_load_dwordx4 v[124:127], v2, s[8:11], s65 offen offset:3072 sc1
  s_branch P3_OK4
P3_RT5:
  s_waitcnt vmcnt(0)
P3_RL5:
  s_sleep 2
  buffer_load_dwordx4 v[136:139], v2, s[8:11], s62 offen offset:1024 sc1
  buffer_load_dwordx4 v[140:143], v2, s[8:11], s63 offen offset:1024 sc1
  s_add_u32 s70, s70, 1
  s_waitcnt vmcnt(0)
  v_max3_u32 v7, v136, v137, v138
  v_max3_u32 v9, v139, v140, v141
  v_max3_u32 v7, v142, v143, v7
  v_max_u32 v7, v7, v9
  v_cmp_eq_u32 vcc, -1, v7
  s_cmp_ge_u32 s70, 65536
  s_cbranch_scc1 P3_RD5
  s_cbranch_vccnz P3_RL5
P3_RD5:
  buffer_load_dwordx4 v[144:147], v2, s[8:11], s62 offen offset:2048 sc1
  buffer_load_dwordx4 v[148:151], v2, s[8:11], s63 offen offset:2048 sc1
  buffer_load_dwordx4 v[152:155], v2, s[8:11], s62 offen offset:3072 sc1
  buffer_load_dwordx4 v[156:159], v2, s[8:11], s63 offen offset:3072 sc1
  buffer_load_dwordx4 v[96:99], v2, s[8:11], s64 offen offset:0 sc1
  buffer_load_dwordx4 v[100:103], v2, s[8:11], s65 offen offset:0 sc1
  buffer_load_dwordx4 v[104:107], v2, s[8:11], s64 offen offset:1024 sc1
  buffer_load_dwordx4 v[108:111], v2, s[8:11], s65 offen offset:1024 sc1
  buffer_load_dwordx4 v[112:115], v2, s[8:11], s64 offen offset:2048 sc1
  buffer_load_dwordx4 v[116:119], v2, s[8:11], s65 offen offset:2048 sc1
  buffer_load_dwordx4 v[120:123], v2, s[8:11], s64 offen offset:3072 sc1
  buffer_load_dwordx4 v[124:127], v2, s[8:11], s65 offen offset:3072 sc1
  buffer_load_dwordx4 v[128:131], v2, s[8:11], s66 offen offset:0 sc1
  buffer_load_dwordx4 v[132:135], v2, s[8:11], s67 offen offset:0 sc1
  s_branch P3_OK5
P3_RT6:
  s_waitcnt vmcnt(0)
P3_RL6:
  s_sleep 2
  buffer_load_dwordx4 v[144:147], v2, s[8:11], s62 offen offset:2048 sc1
  buffer_load_dwordx4 v[148:151], v2, s[8:11], s63 offen offset:2048 sc1
  s_add_u32 s70, s70, 1
  s_waitcnt vmcnt(0)
  v_max3_u32 v7, v144, v145, v146
  v_max3_u32 v9, v147, v148, v149
  v_max3_u32 v7, v150, v151, v7
  v_max_u32 v7, v7, v9
  v_cmp_eq_u32 vcc, -1, v7
  s_cmp_ge_u32 s70, 65536
  s_cbranch_scc1 P3_RD6
  s_cbranch_vccnz P3_RL6
P3_RD6:
  buffer_load_dwordx4 v[152:155], v2, s[8:11], s62 offen offset:3072 sc1
  buffer_load_dwordx4 v[156:159], v2, s[8:11], s63 offen offset:3072 sc1
  buffer_load_dwordx4 v[96:99], v2, s[8:11], s64 offen offset:0 sc1
  buffer_load_dwordx4 v[100:103], v2, s[8:11], s65 offen offset:0 sc1
  buffer_load_dwordx4 v[104:107], v2, s[8:11], s64 offen offset:1024 sc1
  buffer_load_dwordx4 v[108:111], v2, s[8:11], s65 offen offset:1024 sc1
  buffer_load_dwordx4 v[112:115], v2, s[8:11], s64 offen offset:2048 sc1
  buffer_load_dwordx4 v[116:119], v2, s[8:11], s65 offen offset:2048 sc1
  buffer_load_dwordx4 v[120:123], v2, s[8:11], s64 offen offset:3072 sc1
  buffer_load_dwordx4 v[124:127], v2, s[8:11], s65 offen offset:3072 sc1
  buffer_load_dwordx4 v[128:131], v2, s[8:11], s66 offen offset:0 sc1
  buffer_load_dwordx4 v[132:135], v2, s[8:11], s67 offen offset:0 sc1
  buffer_load_dwordx4 v[136:139], v2, s[8:11], s66 offen offset:1024 sc1
  buffer_load_dwordx4 v[140:143], v2, s[8:11], s67 offen offset:1024 sc1
  s_branch P3_OK6
P3_RT7:
  s_waitcnt vmcnt(0)
P3_RL7:
  s_sleep 2
  buffer_load_dwordx4 v[152:155], v2, s[8:11], s62 offen offset:3072 sc1
  buffer_load_dwordx4 v[156:159], v2, s[8:11], s63 offen offset:3072 sc1
  s_add_u32 s70, s70, 1
  s_waitcnt vmcnt(0)
  v_max3_u32 v7, v152, v153, v154
  v_max3_u32 v9, v155, v156, v157
  v_max3_u32 v7, v158, v159, v7
  v_max_u32 v7, v7, v9
  v_cmp_eq_u32 vcc, -1, v7
  s_cmp_ge_u32 s70, 65536
  s_cbranch_scc1 P3_RD7
  s_cbranch_vccnz P3_RL7
P3_RD7:
  buffer_load_dwordx4 v[96:99], v2, s[8:11], s64 offen offset:0 sc1
  buffer_load_dwordx4 v[100:103], v2, s[8:11], s65 offen offset:0 sc1
  buffer_load_dwordx4 v[104:107], v2, s[8:11], s64 offen offset:1024 sc1
  buffer_load_dwordx4 v[108:111], v2, s[8:11], s65 offen offset:1024 sc1
  buffer_load_dwordx4 v[112:115], v2, s[8:11], s64 offen offset:2048 sc1
  buffer_load_dwordx4 v[116:119], v2, s[8:11], s65 offen offset:2048 sc1
  buffer_load_dwordx4 v[120:123], v2, s[8:11], s64 offen offset:3072 sc1
  buffer_load_dwordx4 v[124:127], v2, s[8:11], s65 offen offset:3072 sc1
  buffer_load_dwordx4 v[128:131], v2, s[8:11], s66 offen offset:0 sc1
  buffer_load_dwordx4 v[132:135], v2, s[8:11], s67 offen offset:0 sc1
  buffer_load_dwordx4 v[136:139], v2, s[8:11], s66 offen offset:1024 sc1
  buffer_load_dwordx4 v[140:143], v2, s[8:11], s67 offen offset:1024 sc1
  buffer_load_dwordx4 v[144:147], v2, s[8:11], s66 offen offset:2048 sc1
  buffer_load_dwordx4 v[148:151], v2, s[8:11], s67 offen offset:2048 sc1
  s_branch P3_OK7
P3_RT8:
  s_waitcnt vmcnt(0)
P3_RL8:
  s_sleep 2
  buffer_load_dwordx4 v[96:99], v2, s[8:11], s64 offen offset:0 sc1
  buffer_load_dwordx4 v[100:103], v2, s[8:11], s65 offen offset:0 sc1
  s_add_u32 s70, s70, 1
  s_waitcnt vmcnt(0)
  v_max3_u32 v7, v96, v97, v98
  v_max3_u32 v9, v99, v100, v101
  v_max3_u32 v7, v102, v103, v7
  v_max_u32 v7, v7, v9
  v_cmp_eq_u32 vcc, -1, v7
  s_cmp_ge_u32 s70, 65536
  s_cbranch_scc1 P3_RD8
  s_cbranch_vccnz P3_RL8
P3_RD8:
  buffer_load_dwordx4 v[104:107], v2, s[8:11], s64 offen offset:1024 sc1
  buffer_load_dwordx4 v[108:111], v2, s[8:11], s65 offen offset:1024 sc1
  buffer_load_dwordx4 v[112:115], v2, s[8:11], s64 offen offset:2048 sc1
  buffer_load_dwordx4 v[116:119], v2, s[8:11], s65 offen offset:2048 sc1
  buffer_load_dwordx4 v[120:123], v2, s[8:11], s64 offen offset:3072 sc1
  buffer_load_dwordx4 v[124:127], v2, s[8:11], s65 offen offset:3072 sc1
  buffer_load_dwordx4 v[128:131], v2, s[8:11], s66 offen offset:0 sc1
  buffer_load_dwordx4 v[132:135], v2, s[8:11], s67 offen offset:0 sc1
  buffer_load_dwordx4 v[136:139], v2, s[8:11], s66 offen offset:1024 sc1
  buffer_load_dwordx4 v[140:143], v2, s[8:11], s67 offen offset:1024 sc1
  buffer_load_dwordx4 v[144:147], v2, s[8:11], s66 offen offset:2048 sc1
  buffer_load_dwordx4 v[148:151], v2, s[8:11], s67 offen offset:2048 sc1
  buffer_load_dwordx4 v[152:155], v2, s[8:11], s66 offen offset:3072 sc1
  buffer_load_dwordx4 v[156:159], v2, s[8:11], s67 offen offset:3072 sc1
  s_branch P3_OK8
P3_RT9:
  s_waitcnt vmcnt(0)
P3_RL9:
  s_sleep 2
  buffer_load_dwordx4 v[104:107], v2, s[8:11], s64 offen offset:1024 sc1
  buffer_load_dwordx4 v[108:111], v2, s[8:11], s65 offen offset:1024 sc1
  s_add_u32 s70, s70, 1
  s_waitcnt vmcnt(0)
  v_max3_u32 v7, v104, v105, v106
  v_max3_u32 v9, v107, v108, v109
  v_max3_u32 v7, v110, v111, v7
  v_max_u32 v7, v7, v9
  v_cmp_eq_u32 vcc, -1, v7
  s_cmp_ge_u32 s70, 65536
  s_cbranch_scc1 P3_RD9
  s_cbranch_vccnz P3_RL9
P3_RD9:
  buffer_load_dwordx4 v[112:115], v2, s[8:11], s64 offen offset:2048 sc1
  buffer_load_dwordx4 v[116:119], v2, s[8:11], s65 offen offset:2048 sc1
  buffer_load_dwordx4 v[120:123], v2, s[8:11], s64 offen offset:3072 sc1
  buffer_load_dwordx4 v[124:127], v2, s[8:11], s65 offen offset:3072 sc1
  buffer_load_dwordx4 v[128:131], v2, s[8:11], s66 offen offset:0 sc1
  buffer_load_dwordx4 v[132:135], v2, s[8:11], s67 offen offset:0 sc1
  buffer_load_dwordx4 v[136:139], v2, s[8:11], s66 offen offset:1024 sc1
  buffer_load_dwordx4 v[140:143], v2, s[8:11], s67 offen offset:1024 sc1
  buffer_load_dwordx4 v[144:147], v2, s[8:11], s66 offen offset:2048 sc1
  buffer_load_dwordx4 v[148:151], v2, s[8:11], s67 offen offset:2048 sc1
  buffer_load_dwordx4 v[152:155], v2, s[8:11], s66 offen offset:3072 sc1
  buffer_load_dwordx4 v[156:159], v2, s[8:11], s67 offen offset:3072 sc1
  buffer_load_dwordx4 v[96:99], v2, s[8:11], s68 offen offset:0 sc1
  buffer_load_dwordx4 v[100:103], v2, s[8:11], s69 offen offset:0 sc1
  s_branch P3_OK9
P3_RT10:
  s_waitcnt vmcnt(0)
P3_RL10:
  s_sleep 2
  buffer_load_dwordx4 v[112:115], v2, s[8:11], s64 offen offset:2048 sc1
  buffer_load_dwordx4 v[116:119], v2, s[8:11], s65 offen offset:2048 sc1
  s_add_u32 s70, s70, 1
  s_waitcnt vmcnt(0)
  v_max3_u32 v7, v112, v113, v114
  v_max3_u32 v9, v115, v116, v117
  v_max3_u32 v7, v118, v119, v7
  v_max_u32 v7, v7, v9
  v_cmp_eq_u32 vcc, -1, v7
  s_cmp_ge_u32 s70, 65536
  s_cbranch_scc1 P3_RD10
  s_cbranch_vccnz P3_RL10
P3_RD10:
  buffer_load_dwordx4 v[120:123], v2, s[8:11], s64 offen offset:3072 sc1
  buffer_load_dwordx4 v[124:127], v2, s[8:11], s65 offen offset:3072 sc1
  buffer_load_dwordx4 v[128:131], v2, s[8:11], s66 offen offset:0 sc1
  buffer_load_dwordx4 v[132:135], v2, s[8:11], s67 offen offset:0 sc1
  buffer_load_dwordx4 v[136:139], v2, s[8:11], s66 offen offset:1024 sc1
  buffer_load_dwordx4 v[140:143], v2, s[8:11], s67 offen offset:1024 sc1
  buffer_load_dwordx4 v[144:147], v2, s[8:11], s66 offen offset:2048 sc1
  buffer_load_dwordx4 v[148:151], v2, s[8:11], s67 offen offset:2048 sc1
  buffer_load_dwordx4 v[152:155], v2, s[8:11], s66 offen offset:3072 sc1
  buffer_load_dwordx4 v[156:159], v2, s[8:11], s67 offen offset:3072 sc1
  buffer_load_dwordx4 v[96:99], v2, s[8:11], s68 offen offset:0 sc1
  buffer_load_dwordx4 v[100:103], v2, s[8:11], s69 offen offset:0 sc1
  buffer_load_dwordx4 v[104:107], v2, s[8:11], s68 offen offset:1024 sc1
  buffer_load_dwordx4 v[108:111], v2, s[8:11], s69 offen offset:1024 sc1
  s_branch P3_OK10
P3_RT11:
  s_waitcnt vmcnt(0)
P3_RL11:
  s_sleep 2
  buffer_load_dwordx4 v[120:123], v2, s[8:11], s64 offen offset:3072 sc1
  buffer_load_dwordx4 v[124:127], v2, s[8:11], s65 offen offset:3072 sc1
  s_add_u32 s70, s70, 1
  s_waitcnt vmcnt(0)
  v_max3_u32 v7, v120, v121, v122
  v_max3_u32 v9, v123, v124, v125
  v_max3_u32 v7, v126, v127, v7
  v_max_u32 v7, v7, v9
  v_cmp_eq_u32 vcc, -1, v7
  s_cmp_ge_u32 s70, 65536
  s_cbranch_scc1 P3_RD11
  s_cbranch_vccnz P3_RL11
P3_RD11:
  buffer_load_dwordx4 v[128:131], v2, s[8:11], s66 offen offset:0 sc1
  buffer_load_dwordx4 v[132:135], v2, s[8:11], s67 offen offset:0 sc1
  buffer_load_dwordx4 v[136:139], v2, s[8:11], s66 offen offset:1024 sc1
  buffer_load_dwordx4 v[140:143], v2, s[8:11], s67 offen offset:1024 sc1
  buffer_load_dwordx4 v[144:147], v2, s[8:11], s66 offen offset:2048 sc1
  buffer_load_dwordx4 v[148:151], v2, s[8:11], s67 offen offset:2048 sc1
  buffer_load_dwordx4 v[152:155], v2, s[8:11], s66 offen offset:3072 sc1
  buffer_load_dwordx4 v[156:159], v2, s[8:11], s67 offen offset:3072 sc1
  buffer_load_dwordx4 v[96:99], v2, s[8:11], s68 offen offset:0 sc1
  buffer_load_dwordx4 v[100:103], v2, s[8:11], s69 offen offset:0 sc1
  buffer_load_dwordx4 v[104:107], v2, s[8:11], s68 offen offset:1024 sc1
  buffer_load_dwordx4 v[108:111], v2, s[8:11], s69 offen offset:1024 sc1
  buffer_load_dwordx4 v[112:115], v2, s[8:11], s68 offen offset:2048 sc1
  buffer_load_dwordx4 v[116:119], v2, s[8:11], s69 offen offset:2048 sc1
  s_branch P3_OK11
P3_RT12:
  s_waitcnt vmcnt(0)
P3_RL12:
  s_sleep 2
  buffer_load_dwordx4 v[128:131], v2, s[8:11], s66 offen offset:0 sc1
  buffer_load_dwordx4 v[132:135], v2, s[8:11], s67 offen offset:0 sc1
  s_add_u32 s70, s70, 1
  s_waitcnt vmcnt(0)
  v_max3_u32 v7, v128, v129, v130
  v_max3_u32 v9, v131, v132, v133
  v_max3_u32 v7, v134, v135, v7
  v_max_u32 v7, v7, v9
  v_cmp_eq_u32 vcc, -1, v7
  s_cmp_ge_u32 s70, 65536
  s_cbranch_scc1 P3_RD12
  s_cbranch_vccnz P3_RL12
P3_RD12:
  buffer_load_dwordx4 v[136:139], v2, s[8:11], s66 offen offset:1024 sc1
  buffer_load_dwordx4 v[140:143], v2, s[8:11], s67 offen offset:1024 sc1
  buffer_load_dwordx4 v[144:147], v2, s[8:11], s66 offen offset:2048 sc1
  buffer_load_dwordx4 v[148:151], v2, s[8:11], s67 offen offset:2048 sc1
  buffer_load_dwordx4 v[152:155], v2, s[8:11], s66 offen offset:3072 sc1
  buffer_load_dwordx4 v[156:159], v2, s[8:11], s67 offen offset:3072 sc1
  buffer_load_dwordx4 v[96:99], v2, s[8:11], s68 offen offset:0 sc1
  buffer_load_dwordx4 v[100:103], v2, s[8:11], s69 offen offset:0 sc1
  buffer_load_dwordx4 v[104:107], v2, s[8:11], s68 offen offset:1024 sc1
  buffer_load_dwordx4 v[108:111], v2, s[8:11], s69 offen offset:1024 sc1
  buffer_load_dwordx4 v[112:115], v2, s[8:11], s68 offen offset:2048 sc1
  buffer_load_dwordx4 v[116:119], v2, s[8:11], s69 offen offset:2048 sc1
  buffer_load_dwordx4 v[120:123], v2, s[8:11], s68 offen offset:3072 sc1
  buffer_load_dwordx4 v[124:127], v2, s[8:11], s69 offen offset:3072 sc1
  s_branch P3_OK12
P3_RT13:
  s_waitcnt vmcnt(0)
P3_RL13:
  s_sleep 2
  buffer_load_dwordx4 v[136:139], v2, s[8:11], s66 offen offset:1024 sc1
  buffer_load_dwordx4 v[140:143], v2, s[8:11], s67 offen offset:1024 sc1
  s_add_u32 s70, s70, 1
  s_waitcnt vmcnt(0)
  v_max3_u32 v7, v136, v137, v138
  v_max3_u32 v9, v139, v140, v141
  v_max3_u32 v7, v142, v143, v7
  v_max_u32 v7, v7, v9
  v_cmp_eq_u32 vcc, -1, v7
  s_cmp_ge_u32 s70, 65536
  s_cbranch_scc1 P3_RD13
  s_cbranch_vccnz P3_RL13
P3_RD13:
  buffer_load_dwordx4 v[144:147], v2, s[8:11], s66 offen offset:2048 sc1
  buffer_load_dwordx4 v[148:151], v2, s[8:11], s67 offen offset:2048 sc1
  buffer_load_dwordx4 v[152:155], v2, s[8:11], s66 offen offset:3072 sc1
  buffer_load_dwordx4 v[156:159], v2, s[8:11], s67 offen offset:3072 sc1
  buffer_load_dwordx4 v[96:99], v2, s[8:11], s68 offen offset:0 sc1
  buffer_load_dwordx4 v[100:103], v2, s[8:11], s69 offen offset:0 sc1
  buffer_load_dwordx4 v[104:107], v2, s[8:11], s68 offen offset:1024 sc1
  buffer_load_dwordx4 v[108:111], v2, s[8:11], s69 offen offset:1024 sc1
  buffer_load_dwordx4 v[112:115], v2, s[8:11], s68 offen offset:2048 sc1
  buffer_load_dwordx4 v[116:119], v2, s[8:11], s69 offen offset:2048 sc1
  buffer_load_dwordx4 v[120:123], v2, s[8:11], s68 offen offset:3072 sc1
  buffer_load_dwordx4 v[124:127], v2, s[8:11], s69 offen offset:3072 sc1
  s_branch P3_OK13
P3_RT14:
  s_waitcnt vmcnt(0)
P3_RL14:
  s_sleep 2
  buffer_load_dwordx4 v[144:147], v2, s[8:11], s66 offen offset:2048 sc1
  buffer_load_dwordx4 v[148:151], v2, s[8:11], s67 offen offset:2048 sc1
  s_add_u32 s70, s70, 1
  s_waitcnt vmcnt(0)
  v_max3_u32 v7, v144, v145, v146
  v_max3_u32 v9, v147, v148, v149
  v_max3_u32 v7, v150, v151, v7
  v_max_u32 v7, v7, v9
  v_cmp_eq_u32 vcc, -1, v7
  s_cmp_ge_u32 s70, 65536
  s_cbranch_scc1 P3_RD14
  s_cbranch_vccnz P3_RL14
P3_RD14:
  buffer_load_dwordx4 v[152:155], v2, s[8:11], s66 offen offset:3072 sc1
  buffer_load_dwordx4 v[156:159], v2, s[8:11], s67 offen offset:3072 sc1
  buffer_load_dwordx4 v[96:99], v2, s[8:11], s68 offen offset:0 sc1
  buffer_load_dwordx4 v[100:103], v2, s[8:11], s69 offen offset:0 sc1
  buffer_load_dwordx4 v[104:107], v2, s[8:11], s68 offen offset:1024 sc1
  buffer_load_dwordx4 v[108:111], v2, s[8:11], s69 offen offset:1024 sc1
  buffer_load_dwordx4 v[112:115], v2, s[8:11], s68 offen offset:2048 sc1
  buffer_load_dwordx4 v[116:119], v2, s[8:11], s69 offen offset:2048 sc1
  buffer_load_dwordx4 v[120:123], v2, s[8:11], s68 offen offset:3072 sc1
  buffer_load_dwordx4 v[124:127], v2, s[8:11], s69 offen offset:3072 sc1
  s_branch P3_OK14
P3_RT15:
  s_waitcnt vmcnt(0)
P3_RL15:
  s_sleep 2
  buffer_load_dwordx4 v[152:155], v2, s[8:11], s66 offen offset:3072 sc1
  buffer_load_dwordx4 v[156:159], v2, s[8:11], s67 offen offset:3072 sc1
  s_add_u32 s70, s70, 1
  s_waitcnt vmcnt(0)
  v_max3_u32 v7, v152, v153, v154
  v_max3_u32 v9, v155, v156, v157
  v_max3_u32 v7, v158, v159, v7
  v_max_u32 v7, v7, v9
  v_cmp_eq_u32 vcc, -1, v7
  s_cmp_ge_u32 s70, 65536
  s_cbranch_scc1 P3_RD15
  s_cbranch_vccnz P3_RL15
P3_RD15:
  buffer_load_dwordx4 v[96:99], v2, s[8:11], s68 offen offset:0 sc1
  buffer_load_dwordx4 v[100:103], v2, s[8:11], s69 offen offset:0 sc1
  buffer_load_dwordx4 v[104:107], v2, s[8:11], s68 offen offset:1024 sc1
  buffer_load_dwordx4 v[108:111], v2, s[8:11], s69 offen offset:1024 sc1
  buffer_load_dwordx4 v[112:115], v2, s[8:11], s68 offen offset:2048 sc1
  buffer_load_dwordx4 v[116:119], v2, s[8:11], s69 offen offset:2048 sc1
  buffer_load_dwordx4 v[120:123], v2, s[8:11], s68 offen offset:3072 sc1
  buffer_load_dwordx4 v[124:127], v2, s[8:11], s69 offen offset:3072 sc1
  s_branch P3_OK15
P3_RT16:
  s_waitcnt vmcnt(0)
P3_RL16:
  s_sleep 2
  buffer_load_dwordx4 v[96:99], v2, s[8:11], s68 offen offset:0 sc1
  buffer_load_dwordx4 v[100:103], v2, s[8:11], s69 offen offset:0 sc1
  s_add_u32 s70, s70, 1
  s_waitcnt vmcnt(0)
  v_max3_u32 v7, v96, v97, v98
  v_max3_u32 v9, v99, v100, v101
  v_max3_u32 v7, v102, v103, v7
  v_max_u32 v7, v7, v9
  v_cmp_eq_u32 vcc, -1, v7
  s_cmp_ge_u32 s70, 65536
  s_cbranch_scc1 P3_RD16
  s_cbranch_vccnz P3_RL16
P3_RD16:
  buffer_load_dwordx4 v[104:107], v2, s[8:11], s68 offen offset:1024 sc1
  buffer_load_dwordx4 v[108:111], v2, s[8:11], s69 offen offset:1024 sc1
  buffer_load_dwordx4 v[112:115], v2, s[8:11], s68 offen offset:2048 sc1
  buffer_load_dwordx4 v[116:119], v2, s[8:11], s69 offen offset:2048 sc1
  buffer_load_dwordx4 v[120:123], v2, s[8:11], s68 offen offset:3072 sc1
  buffer_load_dwordx4 v[124:127], v2, s[8:11], s69 offen offset:3072 sc1
  s_branch P3_OK16
P3_RT17:
  s_waitcnt vmcnt(0)
P3_RL17:
  s_sleep 2
  buffer_load_dwordx4 v[104:107], v2, s[8:11], s68 offen offset:1024 sc1
  buffer_load_dwordx4 v[108:111], v2, s[8:11], s69 offen offset:1024 sc1
  s_add_u32 s70, s70, 1
  s_waitcnt vmcnt(0)
  v_max3_u32 v7, v104, v105, v106
  v_max3_u32 v9, v107, v108, v109
  v_max3_u32 v7, v110, v111, v7
  v_max_u32 v7, v7, v9
  v_cmp_eq_u32 vcc, -1, v7
  s_cmp_ge_u32 s70, 65536
  s_cbranch_scc1 P3_RD17
  s_cbranch_vccnz P3_RL17
P3_RD17:
  buffer_load_dwordx4 v[112:115], v2, s[8:11], s68 offen offset:2048 sc1
  buffer_load_dwordx4 v[116:119], v2, s[8:11], s69 offen offset:2048 sc1
  buffer_load_dwordx4 v[120:123], v2, s[8:11], s68 offen offset:3072 sc1
  buffer_load_dwordx4 v[124:127], v2, s[8:11], s69 offen offset:3072 sc1
  s_branch P3_OK17
P3_RT18:
  s_waitcnt vmcnt(0)
P3_RL18:
  s_sleep 2
  buffer_load_dwordx4 v[112:115], v2, s[8:11], s68 offen offset:2048 sc1
  buffer_load_dwordx4 v[116:119], v2, s[8:11], s69 offen offset:2048 sc1
  s_add_u32 s70, s70, 1
  s_waitcnt vmcnt(0)
  v_max3_u32 v7, v112, v113, v114
  v_max3_u32 v9, v115, v116, v117
  v_max3_u32 v7, v118, v119, v7
  v_max_u32 v7, v7, v9
  v_cmp_eq_u32 vcc, -1, v7
  s_cmp_ge_u32 s70, 65536
  s_cbranch_scc1 P3_RD18
  s_cbranch_vccnz P3_RL18
P3_RD18:
  buffer_load_dwordx4 v[120:123], v2, s[8:11], s68 offen offset:3072 sc1
  buffer_load_dwordx4 v[124:127], v2, s[8:11], s69 offen offset:3072 sc1
  s_branch P3_OK18
P3_RT19:
  s_waitcnt vmcnt(0)
P3_RL19:
  s_sleep 2
  buffer_load_dwordx4 v[120:123], v2, s[8:11], s68 offen offset:3072 sc1
  buffer_load_dwordx4 v[124:127], v2, s[8:11], s69 offen offset:3072 sc1
  s_add_u32 s70, s70, 1
  s_waitcnt vmcnt(0)
  v_max3_u32 v7, v120, v121, v122
  v_max3_u32 v9, v123, v124, v125
  v_max3_u32 v7, v126, v127, v7
  v_max_u32 v7, v7, v9
  v_cmp_eq_u32 vcc, -1, v7
  s_cmp_ge_u32 s70, 65536
  s_cbranch_scc1 P3_RD19
  s_cbranch_vccnz P3_RL19
P3_RD19:
  s_branch P3_OK19
.section .rodata,"a"
.p2align 6
.amdhsa_kernel concat_heads__softmax_full_mha__grouped_kv_mqa__prompt_kernel
  .amdhsa_next_free_vgpr 168
  .amdhsa_next_free_sgpr 102
  .amdhsa_accum_offset 168
  .amdhsa_group_segment_fixed_size 0
  .amdhsa_kernarg_size 88
  .amdhsa_user_sgpr_count 2
  .amdhsa_user_sgpr_kernarg_segment_ptr 1
  .amdhsa_system_sgpr_workgroup_id_x 1
.end_amdhsa_kernel
```
